```python
import torch

def _softmax(x, axis=-1):
    return torch.softmax(x, dim=axis)
def _gelu(x):
    return torch.nn.functional.gelu(x, approximate="tanh")
def _silu(x):
    return torch.nn.functional.silu(x)
def _sigmoid(x):
    return torch.sigmoid(x)
def _layernorm(x, axis=-1, eps=1e-5):
    m = x.mean(dim=axis, keepdim=True)
    v = x.var(dim=axis, keepdim=True, unbiased=False)
    return (x - m) / torch.sqrt(v + eps)
def _scatter_add(tgt, idx, src, axis=0):
    return tgt.clone().index_add_(axis, idx, src)
def _segment_sum(src, seg, n):
    out = torch.zeros((n,) + src.shape[1:], dtype=src.dtype)
    return out.index_add_(0, seg, src)
def _pad(x, pw):
    flat = tuple(v for pair in reversed(pw) for v in pair)
    return torch.nn.functional.pad(x, flat)

kernel_name = 'recurrent_scan__spectral_fnet__moe_arch_mod__prompt'

def setup_inputs():

    _w = (lambda a: (lambda t: t.to(torch.bfloat16) if t.is_floating_point() else t)(torch.as_tensor(a)))
    def _A_setup():
        B, S, D = 1, 2048, 448
        ns = torch.arange(S)[:, None] * torch.arange(S)[None, :]
        nd = torch.arange(D)[:, None] * torch.arange(D)[None, :]
        Ws_re = torch.cos(-2.0 * torch.pi * ns / S).to(float)
        Ws_im = torch.sin(-2.0 * torch.pi * ns / S).to(float)
        Wd_re = torch.cos(-2.0 * torch.pi * nd / D).to(float)
        Wd_im = torch.sin(-2.0 * torch.pi * nd / D).to(float)
        return {
            "x": _w((lambda *s: torch.randn(*s, dtype=torch.bfloat16) * 0.05)(B, S, D)),
            "dft_seq_re": _w(Ws_re),
            "dft_seq_im": _w(Ws_im),
            "dft_hid_re": _w(Wd_re),
            "dft_hid_im": _w(Wd_im),
        }
    _A_in = _A_setup()

    def _B_setup():
        B, S, D, F, C = 1, 2048, 448, 1792, 1
        return {
            "x": _w((lambda *s: torch.randn(*s, dtype=torch.bfloat16) * 0.05)(B, S, D)),
            "w_r": _w((lambda *s: torch.randn(*s, dtype=torch.bfloat16) * 0.05)(D)),
            "w_gate": _w((lambda *s: torch.randn(*s, dtype=torch.bfloat16) * 0.05)(D, F)),
            "w_up": _w((lambda *s: torch.randn(*s, dtype=torch.bfloat16) * 0.05)(D, F)),
            "w_down": _w((lambda *s: torch.randn(*s, dtype=torch.bfloat16) * 0.05)(F, D)),
        }
    _B_in = _B_setup()

    return {
        "A_x": _A_in["x"],
        "A_dft_seq_re": _A_in["dft_seq_re"],
        "A_dft_seq_im": _A_in["dft_seq_im"],
        "A_dft_hid_re": _A_in["dft_hid_re"],
        "A_dft_hid_im": _A_in["dft_hid_im"],
        "B_x": _B_in["x"],
        "B_w_r": _B_in["w_r"],
        "B_w_gate": _B_in["w_gate"],
        "B_w_up": _B_in["w_up"],
        "B_w_down": _B_in["w_down"],
    }

def reference(A_x, A_dft_seq_re, A_dft_seq_im, A_dft_hid_re, A_dft_hid_im, B_x, B_w_r, B_w_gate, B_w_up, B_w_down):
    def _A_ref(x, dft_seq_re, dft_seq_im, dft_hid_re, dft_hid_im):
        a = torch.einsum("bsd,ed->bse", x, dft_hid_re)
        b = torch.einsum("bsd,ed->bse", x, dft_hid_im)
        y = torch.einsum("ts,bse->bte", dft_seq_re, a) - torch.einsum("ts,bse->bte", dft_seq_im, b)
        return y

    def _B_ref(x, w_r, w_gate, w_up, w_down):
        B, S, D = x.shape
        C = 1
        r = x @ w_r
        idx = torch.argsort(-r, axis=-1)[:, :C]
        idx_e = (lambda x, n, axis: torch.repeat_interleave(x, n, dim=axis))(idx.reshape(B, C, 1), D, axis=2)
        x_sel = (lambda x, i, axis: torch.take_along_dim(x, i, dim=axis))(x, idx_e, axis=1)
        g = _silu(x_sel @ w_gate)
        u = x_sel @ w_up
        y = (g * u) @ w_down
        r_sel = _sigmoid((lambda x, i, axis: torch.take_along_dim(x, i, dim=axis))(r, idx, axis=1))
        y = y * r_sel.reshape(B, C, 1)
        b_off = (torch.arange(B) * S).reshape(B, 1)
        flat_idx = (idx + b_off).reshape(B * C)
        zero = (x * 0.0).reshape(B * S, D)
        upd = _scatter_add(zero, flat_idx, y.reshape(B * C, D), axis=0)
        return x + upd.reshape(B, S, D)

    x = A_x
    xn = _layernorm(x, axis=-1)
    s = _A_ref(xn, A_dft_seq_re, A_dft_seq_im, A_dft_hid_re, A_dft_hid_im)
    g = _silu(_B_ref(xn, B_w_r, B_w_gate, B_w_up, B_w_down))
    return x + s * g
```

```asm
; @launch grid=(248,1,1) block=(256,1,1) lds=62464
.amdgcn_target "amdgcn-amd-amdhsa--gfx950"
.text
.p2align 12
.fill 832, 4, 0xbf800000
.globl recurrent_scan__spectral_fnet__moe_arch_mod__prompt_kernel
.p2align 8
.type recurrent_scan__spectral_fnet__moe_arch_mod__prompt_kernel,@function
recurrent_scan__spectral_fnet__moe_arch_mod__prompt_kernel:
    s_load_dwordx2 s[12:13], s[0:1], 0
    s_load_dwordx2 s[16:17], s[0:1], 96
    s_load_dwordx2 s[20:21], s[0:1], 80
    s_lshr_b32 s35, s2, 3
    s_cmp_lg_u32 s35, 24
    s_cbranch_scc1 L_nopf
    s_getpc_b64 s[44:45]
L_pc:
    v_lshlrev_b32 v2, 6, v0
    v_min_u32 v2, (L_codeend - L_pc - 4), v2
    global_load_dword v254, v2, s[44:45]
L_nopf:
    v_lshrrev_b32 v2, 6, v0
    v_and_b32 v1, 63, v0
    v_readfirstlane_b32 s28, v2
    s_mov_b32 s14, 1835008
    s_mov_b32 s15, 0x20000
    s_mov_b32 s18, 1572864
    s_mov_b32 s19, 0x20000
    s_mov_b32 s6, 1605632
    s_mov_b32 s7, 0x20000
    s_and_b32 s44, s28, 1
    s_lshl3_add_u32 s44, s44, 56
    s_load_dwordx2 s[4:5], s[0:1], s44
    s_mov_b32 s41, 0
    s_mov_b32 s43, 0x3f803f80
    s_and_b32 s33, s2, 7
    v_lshrrev_b32 v4, 4, v1
    v_and_b32 v5, 15, v0
    s_sub_u32 s34, 16, s33
    s_cmp_eq_u32 s33, 0
    s_cselect_b32 s34, 8, s34
    s_bitcmp1_b32 s2, 3
    s_cselect_b32 s30, s34, s33
    s_and_b32 s45, s2, 0x30
    s_add_u32 s30, s30, s45
    s_cmp_ge_u32 s2, 192
    s_cbranch_scc1 L_ffn
    s_cmp_ge_u32 s2, 64
    s_cbranch_scc1 L_p1
    s_load_dwordx2 s[24:25], s[0:1], 48
    s_mov_b32 s26, 896
    s_mov_b32 s27, 0x20000
    s_sub_u32 s45, 128, s30
    s_cmp_eq_u32 s30, 0
    s_cselect_b32 s45, 64, s45
    s_cmp_ge_u32 s28, 2
    s_cselect_b32 s59, s45, s30
    v_bfe_u32 v13, v0, 3, 4
    v_lshl_add_u32 v6, v13, 7, s59
    v_and_b32 v14, 7, v0
    v_lshlrev_b32 v14, 4, v14
    v_lshlrev_b32 v15, 4, v1
    s_movk_i32 s45, 896
    v_mad_u32_u24 v7, v6, s45, v14
    s_waitcnt lgkmcnt(0)
    buffer_load_dwordx4 v[72:75], v15, s[24:27], 0 offen
    buffer_load_dword v254, off, s[16:19], 0
    s_barrier
    buffer_load_dwordx4 v[16:19], v7, s[12:15], 0 offen offset:768
    s_barrier
    buffer_load_dwordx4 v[20:23], v7, s[12:15], 0 offen offset:640
    s_barrier
    buffer_load_dwordx4 v[24:27], v7, s[12:15], 0 offen offset:512
    s_barrier
    buffer_load_dwordx4 v[28:31], v7, s[12:15], 0 offen offset:384
    s_barrier
    buffer_load_dwordx4 v[32:35], v7, s[12:15], 0 offen offset:256
    s_barrier
    buffer_load_dwordx4 v[36:39], v7, s[12:15], 0 offen offset:128
    s_barrier
    buffer_load_dwordx4 v[40:43], v7, s[12:15], 0 offen offset:0
    s_branch L_router
L_p1:
    s_load_dwordx2 s[8:9], s[0:1], 72
    s_lshr_b32 s31, s2, 7
    s_cmp_eq_u32 s30, 0
    s_cselect_b32 s36, 64, 128
    v_lshrrev_b32 v3, 4, v0
    v_mul_u32_u24 v3, s36, v3
    v_add_u32 v3, s30, v3
    v_sub_u32 v14, 2048, v3
    v_lshrrev_b32 v2, 11, v14
    v_lshrrev_b32 v14, v2, v14
    v_lshlrev_b32 v2, 4, v5
    s_movk_i32 s45, 896
    v_cmp_gt_u32 vcc, 12, v5
    s_min_u32 s49, s30, s31
    s_cmp_eq_u32 s49, 0
    s_mov_b32 s49, 0x3b124925
    s_cbranch_scc1 L_nosw
    v_swap_b32 v3, v14
    s_bitset1_b32 s49, 31
L_nosw:
    v_mad_u32_u24 v6, v3, s45, v2
    v_mad_u32_u24 v7, v14, s45, v2
    v_cndmask_b32 v8, 2.0, v6, vcc
    v_cndmask_b32 v9, 2.0, v7, vcc
    s_mul_i32 s45, s28, 28
    s_add_u32 s45, s45, s31
    s_sub_u32 s45, s45, 3
    v_lshl_add_u32 v3, v5, 1, s45
    v_cvt_f32_i32 v10, v3
    v_mul_f32 v10, s49, v10
    v_lshlrev_b32 v3, 3, v4
    v_cvt_f32_u32 v3, v3
    v_mul_f32 v3, v3, v10
    v_mul_f32 v11, 0x42000000, v10
    v_cos_f32 v14, v10
    v_cos_f32 v12, v11
    v_cos_f32 v176, v3
    v_sin_f32 v177, v3
    v_add_f32 v2, v3, v11
    v_cos_f32 v192, v2
    v_sin_f32 v193, v2
    v_add_f32 v3, v3, v10
    v_cos_f32 v178, v3
    v_sin_f32 v179, v3
    v_add_f32 v2, v3, v11
    v_cos_f32 v194, v2
    v_sin_f32 v195, v2
    v_add_f32 v14, v14, v14
    v_add_f32 v12, v12, v12
    v_pk_fma_f32 v[180:181], v[14:15], v[178:179], v[176:177] op_sel_hi:[0,1,1] neg_lo:[0,0,1] neg_hi:[0,0,1]
    v_pk_fma_f32 v[196:197], v[14:15], v[194:195], v[192:193] op_sel_hi:[0,1,1] neg_lo:[0,0,1] neg_hi:[0,0,1]
    v_pk_fma_f32 v[182:183], v[14:15], v[180:181], v[178:179] op_sel_hi:[0,1,1] neg_lo:[0,0,1] neg_hi:[0,0,1]
    v_pk_fma_f32 v[198:199], v[14:15], v[196:197], v[194:195] op_sel_hi:[0,1,1] neg_lo:[0,0,1] neg_hi:[0,0,1]
    v_pk_fma_f32 v[184:185], v[14:15], v[182:183], v[180:181] op_sel_hi:[0,1,1] neg_lo:[0,0,1] neg_hi:[0,0,1]
    v_pk_fma_f32 v[200:201], v[14:15], v[198:199], v[196:197] op_sel_hi:[0,1,1] neg_lo:[0,0,1] neg_hi:[0,0,1]
    v_pk_fma_f32 v[186:187], v[14:15], v[184:185], v[182:183] op_sel_hi:[0,1,1] neg_lo:[0,0,1] neg_hi:[0,0,1]
    v_pk_fma_f32 v[202:203], v[14:15], v[200:201], v[198:199] op_sel_hi:[0,1,1] neg_lo:[0,0,1] neg_hi:[0,0,1]
    v_pk_fma_f32 v[188:189], v[14:15], v[186:187], v[184:185] op_sel_hi:[0,1,1] neg_lo:[0,0,1] neg_hi:[0,0,1]
    v_pk_fma_f32 v[204:205], v[14:15], v[202:203], v[200:201] op_sel_hi:[0,1,1] neg_lo:[0,0,1] neg_hi:[0,0,1]
    v_pk_fma_f32 v[190:191], v[14:15], v[188:189], v[186:187] op_sel_hi:[0,1,1] neg_lo:[0,0,1] neg_hi:[0,0,1]
    v_pk_fma_f32 v[206:207], v[14:15], v[204:205], v[202:203] op_sel_hi:[0,1,1] neg_lo:[0,0,1] neg_hi:[0,0,1]
    s_waitcnt lgkmcnt(0)
    buffer_load_dwordx4 v[16:19], v6, s[12:15], 0 offen offset:0
    buffer_load_dwordx4 v[20:23], v8, s[12:15], 0 offen offset:256
    v_cvt_pk_bf16_f32 v48, v176, v180
    v_cvt_pk_bf16_f32 v49, v184, v188
    v_cvt_pk_bf16_f32 v64, v178, v182
    v_cvt_pk_bf16_f32 v65, v186, v190
    v_cvt_pk_bf16_f32 v80, v177, v181
    v_cvt_pk_bf16_f32 v81, v185, v189
    v_cvt_pk_bf16_f32 v96, v179, v183
    v_cvt_pk_bf16_f32 v97, v187, v191
    v_cvt_pk_bf16_f32 v52, v192, v196
    v_cvt_pk_bf16_f32 v53, v200, v204
    buffer_load_dwordx4 v[24:27], v6, s[12:15], 0 offen offset:448
    v_cvt_pk_bf16_f32 v68, v194, v198
    v_cvt_pk_bf16_f32 v69, v202, v206
    v_cvt_pk_bf16_f32 v84, v193, v197
    v_cvt_pk_bf16_f32 v85, v201, v205
    v_cvt_pk_bf16_f32 v100, v195, v199
    v_cvt_pk_bf16_f32 v101, v203, v207
    v_pk_fma_f32 v[176:177], v[12:13], v[192:193], v[176:177] op_sel_hi:[0,1,1] neg_lo:[0,0,1] neg_hi:[0,0,1]
    v_pk_fma_f32 v[178:179], v[12:13], v[194:195], v[178:179] op_sel_hi:[0,1,1] neg_lo:[0,0,1] neg_hi:[0,0,1]
    v_pk_fma_f32 v[180:181], v[12:13], v[196:197], v[180:181] op_sel_hi:[0,1,1] neg_lo:[0,0,1] neg_hi:[0,0,1]
    v_pk_fma_f32 v[182:183], v[12:13], v[198:199], v[182:183] op_sel_hi:[0,1,1] neg_lo:[0,0,1] neg_hi:[0,0,1]
    buffer_load_dwordx4 v[28:31], v8, s[12:15], 0 offen offset:704
    v_pk_fma_f32 v[184:185], v[12:13], v[200:201], v[184:185] op_sel_hi:[0,1,1] neg_lo:[0,0,1] neg_hi:[0,0,1]
    v_pk_fma_f32 v[186:187], v[12:13], v[202:203], v[186:187] op_sel_hi:[0,1,1] neg_lo:[0,0,1] neg_hi:[0,0,1]
    v_pk_fma_f32 v[188:189], v[12:13], v[204:205], v[188:189] op_sel_hi:[0,1,1] neg_lo:[0,0,1] neg_hi:[0,0,1]
    v_pk_fma_f32 v[190:191], v[12:13], v[206:207], v[190:191] op_sel_hi:[0,1,1] neg_lo:[0,0,1] neg_hi:[0,0,1]
    v_cvt_pk_bf16_f32 v56, v176, v180
    v_cvt_pk_bf16_f32 v57, v184, v188
    v_cvt_pk_bf16_f32 v72, v178, v182
    v_cvt_pk_bf16_f32 v73, v186, v190
    v_cvt_pk_bf16_f32 v88, v177, v181
    v_cvt_pk_bf16_f32 v89, v185, v189
    buffer_load_dwordx4 v[32:35], v7, s[12:15], 0 offen offset:0
    v_cvt_pk_bf16_f32 v104, v179, v183
    v_cvt_pk_bf16_f32 v105, v187, v191
    v_pk_fma_f32 v[192:193], v[12:13], v[176:177], v[192:193] op_sel_hi:[0,1,1] neg_lo:[0,0,1] neg_hi:[0,0,1]
    v_pk_fma_f32 v[194:195], v[12:13], v[178:179], v[194:195] op_sel_hi:[0,1,1] neg_lo:[0,0,1] neg_hi:[0,0,1]
    v_pk_fma_f32 v[196:197], v[12:13], v[180:181], v[196:197] op_sel_hi:[0,1,1] neg_lo:[0,0,1] neg_hi:[0,0,1]
    v_pk_fma_f32 v[198:199], v[12:13], v[182:183], v[198:199] op_sel_hi:[0,1,1] neg_lo:[0,0,1] neg_hi:[0,0,1]
    v_pk_fma_f32 v[200:201], v[12:13], v[184:185], v[200:201] op_sel_hi:[0,1,1] neg_lo:[0,0,1] neg_hi:[0,0,1]
    v_pk_fma_f32 v[202:203], v[12:13], v[186:187], v[202:203] op_sel_hi:[0,1,1] neg_lo:[0,0,1] neg_hi:[0,0,1]
    v_pk_fma_f32 v[204:205], v[12:13], v[188:189], v[204:205] op_sel_hi:[0,1,1] neg_lo:[0,0,1] neg_hi:[0,0,1]
    v_pk_fma_f32 v[206:207], v[12:13], v[190:191], v[206:207] op_sel_hi:[0,1,1] neg_lo:[0,0,1] neg_hi:[0,0,1]
    buffer_load_dwordx4 v[36:39], v9, s[12:15], 0 offen offset:256
    v_cvt_pk_bf16_f32 v60, v192, v196
    v_cvt_pk_bf16_f32 v61, v200, v204
    v_cvt_pk_bf16_f32 v76, v194, v198
    v_cvt_pk_bf16_f32 v77, v202, v206
    v_cvt_pk_bf16_f32 v92, v193, v197
    v_cvt_pk_bf16_f32 v93, v201, v205
    v_cvt_pk_bf16_f32 v108, v195, v199
    v_cvt_pk_bf16_f32 v109, v203, v207
    v_pk_fma_f32 v[176:177], v[12:13], v[192:193], v[176:177] op_sel_hi:[0,1,1] neg_lo:[0,0,1] neg_hi:[0,0,1]
    v_pk_fma_f32 v[178:179], v[12:13], v[194:195], v[178:179] op_sel_hi:[0,1,1] neg_lo:[0,0,1] neg_hi:[0,0,1]
    buffer_load_dwordx4 v[40:43], v7, s[12:15], 0 offen offset:448
    v_pk_fma_f32 v[180:181], v[12:13], v[196:197], v[180:181] op_sel_hi:[0,1,1] neg_lo:[0,0,1] neg_hi:[0,0,1]
    v_pk_fma_f32 v[182:183], v[12:13], v[198:199], v[182:183] op_sel_hi:[0,1,1] neg_lo:[0,0,1] neg_hi:[0,0,1]
    v_pk_fma_f32 v[184:185], v[12:13], v[200:201], v[184:185] op_sel_hi:[0,1,1] neg_lo:[0,0,1] neg_hi:[0,0,1]
    v_pk_fma_f32 v[186:187], v[12:13], v[202:203], v[186:187] op_sel_hi:[0,1,1] neg_lo:[0,0,1] neg_hi:[0,0,1]
    v_pk_fma_f32 v[188:189], v[12:13], v[204:205], v[188:189] op_sel_hi:[0,1,1] neg_lo:[0,0,1] neg_hi:[0,0,1]
    v_pk_fma_f32 v[190:191], v[12:13], v[206:207], v[190:191] op_sel_hi:[0,1,1] neg_lo:[0,0,1] neg_hi:[0,0,1]
    v_cvt_pk_bf16_f32 v50, v176, v180
    v_cvt_pk_bf16_f32 v51, v184, v188
    v_cvt_pk_bf16_f32 v66, v178, v182
    v_cvt_pk_bf16_f32 v67, v186, v190
    buffer_load_dwordx4 v[44:47], v9, s[12:15], 0 offen offset:704
    v_cvt_pk_bf16_f32 v82, v177, v181
    v_cvt_pk_bf16_f32 v83, v185, v189
    v_cvt_pk_bf16_f32 v98, v179, v183
    v_cvt_pk_bf16_f32 v99, v187, v191
    v_pk_fma_f32 v[192:193], v[12:13], v[176:177], v[192:193] op_sel_hi:[0,1,1] neg_lo:[0,0,1] neg_hi:[0,0,1]
    v_pk_fma_f32 v[194:195], v[12:13], v[178:179], v[194:195] op_sel_hi:[0,1,1] neg_lo:[0,0,1] neg_hi:[0,0,1]
    v_pk_fma_f32 v[196:197], v[12:13], v[180:181], v[196:197] op_sel_hi:[0,1,1] neg_lo:[0,0,1] neg_hi:[0,0,1]
    v_pk_fma_f32 v[198:199], v[12:13], v[182:183], v[198:199] op_sel_hi:[0,1,1] neg_lo:[0,0,1] neg_hi:[0,0,1]
    v_pk_fma_f32 v[200:201], v[12:13], v[184:185], v[200:201] op_sel_hi:[0,1,1] neg_lo:[0,0,1] neg_hi:[0,0,1]
    v_pk_fma_f32 v[202:203], v[12:13], v[186:187], v[202:203] op_sel_hi:[0,1,1] neg_lo:[0,0,1] neg_hi:[0,0,1]
    s_load_dword s29, s[16:17], 0
    v_pk_fma_f32 v[204:205], v[12:13], v[188:189], v[204:205] op_sel_hi:[0,1,1] neg_lo:[0,0,1] neg_hi:[0,0,1]
    v_pk_fma_f32 v[206:207], v[12:13], v[190:191], v[206:207] op_sel_hi:[0,1,1] neg_lo:[0,0,1] neg_hi:[0,0,1]
    v_cvt_pk_bf16_f32 v54, v192, v196
    v_cvt_pk_bf16_f32 v55, v200, v204
    v_cvt_pk_bf16_f32 v70, v194, v198
    v_cvt_pk_bf16_f32 v71, v202, v206
    v_cvt_pk_bf16_f32 v86, v193, v197
    v_cvt_pk_bf16_f32 v87, v201, v205
    v_cvt_pk_bf16_f32 v102, v195, v199
    v_cvt_pk_bf16_f32 v103, v203, v207
    v_pk_fma_f32 v[176:177], v[12:13], v[192:193], v[176:177] op_sel_hi:[0,1,1] neg_lo:[0,0,1] neg_hi:[0,0,1]
    v_pk_fma_f32 v[178:179], v[12:13], v[194:195], v[178:179] op_sel_hi:[0,1,1] neg_lo:[0,0,1] neg_hi:[0,0,1]
    v_pk_fma_f32 v[180:181], v[12:13], v[196:197], v[180:181] op_sel_hi:[0,1,1] neg_lo:[0,0,1] neg_hi:[0,0,1]
    v_pk_fma_f32 v[182:183], v[12:13], v[198:199], v[182:183] op_sel_hi:[0,1,1] neg_lo:[0,0,1] neg_hi:[0,0,1]
    v_pk_fma_f32 v[184:185], v[12:13], v[200:201], v[184:185] op_sel_hi:[0,1,1] neg_lo:[0,0,1] neg_hi:[0,0,1]
    v_pk_fma_f32 v[186:187], v[12:13], v[202:203], v[186:187] op_sel_hi:[0,1,1] neg_lo:[0,0,1] neg_hi:[0,0,1]
    v_pk_fma_f32 v[188:189], v[12:13], v[204:205], v[188:189] op_sel_hi:[0,1,1] neg_lo:[0,0,1] neg_hi:[0,0,1]
    v_pk_fma_f32 v[190:191], v[12:13], v[206:207], v[190:191] op_sel_hi:[0,1,1] neg_lo:[0,0,1] neg_hi:[0,0,1]
    v_cvt_pk_bf16_f32 v58, v176, v180
    v_cvt_pk_bf16_f32 v59, v184, v188
    v_cvt_pk_bf16_f32 v74, v178, v182
    v_cvt_pk_bf16_f32 v75, v186, v190
    v_cvt_pk_bf16_f32 v90, v177, v181
    v_cvt_pk_bf16_f32 v91, v185, v189
    v_cvt_pk_bf16_f32 v106, v179, v183
    v_cvt_pk_bf16_f32 v107, v187, v191
    s_mov_b32 s10, s6
    s_mov_b32 s11, 0x20000
    s_lshl4_add_u32 s101, s33, s35
    s_lshl2_add_u32 s101, s101, s28
    s_sub_u32 s101, s101, 32
    s_mul_i32 s101, s101, 3136
    v_lshlrev_b32 v7, 7, v1
    v_lshlrev_b32 v2, 2, v4
    v_mul_u32_u24 v2, s36, v2
    v_add_u32 v2, s30, v2
    v_mul_u32_u24 v2, v2, v5
    v_mul_u32_u24 v3, s36, v5
    v_cvt_f32_u32 v2, v2
    v_cvt_f32_u32 v3, v3
    v_mul_f32 v2, 0x3a000000, v2
    v_mul_f32 v3, 0x3a000000, v3
    v_cos_f32 v176, v2
    v_sin_f32 v180, v2
    v_add_f32 v2, v2, v3
    v_cos_f32 v177, v2
    v_sin_f32 v181, v2
    v_add_f32 v2, v2, v3
    v_cos_f32 v178, v2
    v_sin_f32 v182, v2
    v_add_f32 v2, v2, v3
    v_cos_f32 v179, v2
    v_sin_f32 v183, v2
    s_lshr_b32 s44, s28, 1
    s_lshl1_add_u32 s44, s35, s44
    s_mul_i32 s44, s44, 35840
    s_mul_i32 s48, s31, 229376
    s_mul_i32 s45, s33, 448
    s_and_b32 s45, s45, 0xffffff80
    s_add_u32 s44, s44, s48
    s_add_u32 s44, s44, s45
    s_sub_u32 s44, s44, 344064
    v_lshrrev_b32 v252, 2, v1
    v_mul_u32_u24 v252, 3584, v252
    v_and_b32 v253, 3, v0
    v_lshl_add_u32 v252, v253, 7, v252
    s_mov_b32 exec_hi, 0xff
    buffer_load_dword v255, v252, s[4:7], s44 offen
    s_mov_b32 exec_hi, -1
    s_mov_b32 s46, 0xbf317218
    v_pk_mul_f32 v[176:177], v[176:177], s[46:47] op_sel_hi:[1,0]
    v_pk_mul_f32 v[178:179], v[178:179], s[46:47] op_sel_hi:[1,0]
    v_pk_mul_f32 v[180:181], v[180:181], s[46:47] op_sel_hi:[1,0]
    v_pk_mul_f32 v[182:183], v[182:183], s[46:47] op_sel_hi:[1,0]
    v_cvt_pk_bf16_f32 v168, v176, v177
    v_cvt_pk_bf16_f32 v169, v178, v179
    v_cvt_pk_bf16_f32 v170, -v180, -v181
    v_cvt_pk_bf16_f32 v171, -v182, -v183
    v_cvt_pk_bf16_f32 v172, v180, v181
    v_cvt_pk_bf16_f32 v173, v182, v183
    v_mov_b32 v174, v168
    v_mov_b32 v175, v169
    s_mov_b32 s32, 0xffff0000
    v_mov_b32 v8, 1.0
    s_cmp_eq_u32 s30, 0
    s_cbranch_scc1 L_m1f
L_m1d:
    s_mov_b64 exec, 0x1ffffff
    buffer_load_dword v255, v7, s[8:11], s101 offen
    s_mov_b64 exec, -1
    v_lshlrev_b32 v2, 18, v4
    s_lshl_b32 s44, s28, 7
    v_lshl_add_u32 v3, v5, 2, s44
    v_add_u32 v10, v3, v2
    v_add_u32 v3, s31, v5
    v_cmp_gt_u32 vcc, 2, v3
    v_sub_u32 v3, 17, v3
    s_sub_u32 s44, 896, s44
    v_cndmask_b32 v3, v3, v5, vcc
    v_lshl_add_u32 v3, v3, 2, s44
    v_add_u32 v6, v3, v2
    s_lshl4_add_u32 s57, s30, s31
    s_lshl_b32 s57, s57, 6
    s_add_u32 s57, s57, 524288
    s_mov_b32 s50, 0xfffefffe
    s_mov_b32 s51, s50
    s_add_u32 s98, s57, 65536
    s_add_u32 s99, s57, 131072
    s_add_u32 s100, s57, 196608
    v_mov_b32 v3, 0
    ds_write_b32 v3, v3 offset:16388
    v_lshrrev_b32 v2, 4, v0
    v_and_b32 v14, 7, v0
    v_xor_b32 v2, v2, v14
    v_lshlrev_b32 v2, 4, v2
    v_lshl_add_u32 v11, v5, 8, v2
    v_xor_b32 v2, v5, v4
    v_lshlrev_b32 v2, 4, v2
    v_lshl_add_u32 v12, v4, 8, v2
    v_xor_b32 v13, 64, v12
    v_mov_b32 v176, 0
    v_mov_b32 v177, 0
    v_mov_b32 v178, 0x3992ccf7
    v_mov_b32 v179, v178
    s_cmp_eq_u32 s31, 0
    s_movk_i32 s24, 0x3f80
    s_cselect_b32 s24, 0xbf80, s24
    s_cselect_b32 s26, 0, 2.0
    s_lshl_b32 s25, s24, 16
    s_waitcnt vmcnt(9)
    v_dot2c_f32_bf16 v176, s43, v16
    v_dot2c_f32_bf16 v178, v16, v16
    v_dot2c_f32_bf16 v176, s43, v17
    v_dot2c_f32_bf16 v178, v17, v17
    v_dot2c_f32_bf16 v176, s43, v18
    v_dot2c_f32_bf16 v178, v18, v18
    v_dot2c_f32_bf16 v176, s43, v19
    v_dot2c_f32_bf16 v178, v19, v19
    v_lshlrev_b32 v208, 16, v16
    v_and_b32 v209, s32, v16
    v_lshlrev_b32 v210, 16, v17
    v_and_b32 v211, s32, v17
    v_lshlrev_b32 v212, 16, v18
    v_and_b32 v213, s32, v18
    v_lshlrev_b32 v214, 16, v19
    v_and_b32 v215, s32, v19
    s_waitcnt vmcnt(8)
    v_dot2c_f32_bf16 v176, s43, v20
    v_dot2c_f32_bf16 v178, v20, v20
    v_dot2c_f32_bf16 v176, s43, v21
    v_dot2c_f32_bf16 v178, v21, v21
    v_dot2c_f32_bf16 v176, s43, v22
    v_dot2c_f32_bf16 v178, v22, v22
    v_dot2c_f32_bf16 v176, s43, v23
    v_dot2c_f32_bf16 v178, v23, v23
    v_lshlrev_b32 v216, 16, v20
    v_and_b32 v217, s32, v20
    v_lshlrev_b32 v218, 16, v21
    v_and_b32 v219, s32, v21
    v_lshlrev_b32 v220, 16, v22
    v_and_b32 v221, s32, v22
    v_lshlrev_b32 v222, 16, v23
    v_and_b32 v223, s32, v23
    s_waitcnt vmcnt(7)
    v_dot2c_f32_bf16 v176, s43, v24
    v_dot2c_f32_bf16 v178, v24, v24
    v_dot2c_f32_bf16 v176, s43, v25
    v_dot2c_f32_bf16 v178, v25, v25
    v_dot2c_f32_bf16 v176, s43, v26
    v_dot2c_f32_bf16 v178, v26, v26
    v_dot2c_f32_bf16 v176, s43, v27
    v_dot2c_f32_bf16 v178, v27, v27
    v_dot2c_f32_bf16 v208, s24, v24
    v_dot2c_f32_bf16 v209, s25, v24
    v_dot2c_f32_bf16 v210, s24, v25
    v_dot2c_f32_bf16 v211, s25, v25
    v_dot2c_f32_bf16 v212, s24, v26
    v_dot2c_f32_bf16 v213, s25, v26
    v_dot2c_f32_bf16 v214, s24, v27
    v_dot2c_f32_bf16 v215, s25, v27
    s_waitcnt vmcnt(6)
    v_dot2c_f32_bf16 v176, s43, v28
    v_dot2c_f32_bf16 v178, v28, v28
    v_dot2c_f32_bf16 v176, s43, v29
    v_dot2c_f32_bf16 v178, v29, v29
    v_dot2c_f32_bf16 v176, s43, v30
    v_dot2c_f32_bf16 v178, v30, v30
    v_dot2c_f32_bf16 v176, s43, v31
    v_dot2c_f32_bf16 v178, v31, v31
    v_dot2c_f32_bf16 v216, s24, v28
    v_dot2c_f32_bf16 v217, s25, v28
    v_add_f32_dpp v176, v176, v176 row_ror:1 row_mask:0xf bank_mask:0xf
    v_add_f32_dpp v178, v178, v178 row_ror:1 row_mask:0xf bank_mask:0xf
    v_dot2c_f32_bf16 v218, s24, v29
    v_add_f32_dpp v176, v176, v176 row_ror:2 row_mask:0xf bank_mask:0xf
    v_add_f32_dpp v178, v178, v178 row_ror:2 row_mask:0xf bank_mask:0xf
    v_dot2c_f32_bf16 v219, s25, v29
    v_add_f32_dpp v176, v176, v176 row_ror:4 row_mask:0xf bank_mask:0xf
    v_add_f32_dpp v178, v178, v178 row_ror:4 row_mask:0xf bank_mask:0xf
    v_dot2c_f32_bf16 v220, s24, v30
    v_add_f32_dpp v176, v176, v176 row_ror:8 row_mask:0xf bank_mask:0xf
    v_add_f32_dpp v178, v178, v178 row_ror:8 row_mask:0xf bank_mask:0xf
    v_dot2c_f32_bf16 v221, s25, v30
    v_mul_f32 v2, 0xbb124925, v176
    v_mul_f32 v178, 0x3b124925, v178
    v_fma_f32 v178, -v2, v2, v178
    v_rsq_f32 v180, v178
    v_cvt_pk_bf16_f32 v2, 0, v2
    v_mul_f32 v176, s26, v2
    v_dot2c_f32_bf16 v222, s24, v31
    v_dot2c_f32_bf16 v223, s25, v31
    v_mul_f32 v182, v176, v180
    v_pk_fma_f32 v[208:209], v[208:209], v[180:181], v[182:183] op_sel:[0,0,0] op_sel_hi:[1,0,0]
    v_pk_fma_f32 v[210:211], v[210:211], v[180:181], v[182:183] op_sel:[0,0,0] op_sel_hi:[1,0,0]
    v_pk_fma_f32 v[212:213], v[212:213], v[180:181], v[182:183] op_sel:[0,0,0] op_sel_hi:[1,0,0]
    v_pk_fma_f32 v[214:215], v[214:215], v[180:181], v[182:183] op_sel:[0,0,0] op_sel_hi:[1,0,0]
    v_pk_fma_f32 v[216:217], v[216:217], v[180:181], v[182:183] op_sel:[0,0,0] op_sel_hi:[1,0,0]
    v_pk_fma_f32 v[218:219], v[218:219], v[180:181], v[182:183] op_sel:[0,0,0] op_sel_hi:[1,0,0]
    v_pk_fma_f32 v[220:221], v[220:221], v[180:181], v[182:183] op_sel:[0,0,0] op_sel_hi:[1,0,0]
    v_pk_fma_f32 v[222:223], v[222:223], v[180:181], v[182:183] op_sel:[0,0,0] op_sel_hi:[1,0,0]
    s_waitcnt vmcnt(5)
    v_dot2c_f32_bf16 v177, s43, v32
    v_dot2c_f32_bf16 v179, v32, v32
    v_dot2c_f32_bf16 v177, s43, v33
    v_dot2c_f32_bf16 v179, v33, v33
    v_dot2c_f32_bf16 v177, s43, v34
    v_dot2c_f32_bf16 v179, v34, v34
    v_dot2c_f32_bf16 v177, s43, v35
    v_dot2c_f32_bf16 v179, v35, v35
    v_lshlrev_b32 v224, 16, v32
    v_and_b32 v225, s32, v32
    v_lshlrev_b32 v226, 16, v33
    v_and_b32 v227, s32, v33
    v_lshlrev_b32 v228, 16, v34
    v_and_b32 v229, s32, v34
    v_lshlrev_b32 v230, 16, v35
    v_and_b32 v231, s32, v35
    s_waitcnt vmcnt(4)
    v_dot2c_f32_bf16 v177, s43, v36
    v_dot2c_f32_bf16 v179, v36, v36
    v_dot2c_f32_bf16 v177, s43, v37
    v_dot2c_f32_bf16 v179, v37, v37
    v_dot2c_f32_bf16 v177, s43, v38
    v_dot2c_f32_bf16 v179, v38, v38
    v_dot2c_f32_bf16 v177, s43, v39
    v_dot2c_f32_bf16 v179, v39, v39
    v_lshlrev_b32 v232, 16, v36
    v_and_b32 v233, s32, v36
    v_lshlrev_b32 v234, 16, v37
    v_and_b32 v235, s32, v37
    v_lshlrev_b32 v236, 16, v38
    v_and_b32 v237, s32, v38
    v_lshlrev_b32 v238, 16, v39
    v_and_b32 v239, s32, v39
    s_waitcnt vmcnt(3)
    v_dot2c_f32_bf16 v177, s43, v40
    v_dot2c_f32_bf16 v179, v40, v40
    v_dot2c_f32_bf16 v177, s43, v41
    v_dot2c_f32_bf16 v179, v41, v41
    v_dot2c_f32_bf16 v177, s43, v42
    v_dot2c_f32_bf16 v179, v42, v42
    v_dot2c_f32_bf16 v177, s43, v43
    v_dot2c_f32_bf16 v179, v43, v43
    v_dot2c_f32_bf16 v224, s24, v40
    v_dot2c_f32_bf16 v225, s25, v40
    v_dot2c_f32_bf16 v226, s24, v41
    v_dot2c_f32_bf16 v227, s25, v41
    v_dot2c_f32_bf16 v228, s24, v42
    v_dot2c_f32_bf16 v229, s25, v42
    v_dot2c_f32_bf16 v230, s24, v43
    v_dot2c_f32_bf16 v231, s25, v43
    s_waitcnt vmcnt(2)
    v_dot2c_f32_bf16 v177, s43, v44
    v_dot2c_f32_bf16 v179, v44, v44
    v_dot2c_f32_bf16 v177, s43, v45
    v_dot2c_f32_bf16 v179, v45, v45
    v_dot2c_f32_bf16 v177, s43, v46
    v_dot2c_f32_bf16 v179, v46, v46
    v_dot2c_f32_bf16 v177, s43, v47
    v_dot2c_f32_bf16 v179, v47, v47
    v_dot2c_f32_bf16 v232, s24, v44
    v_dot2c_f32_bf16 v233, s25, v44
    v_add_f32_dpp v177, v177, v177 row_ror:1 row_mask:0xf bank_mask:0xf
    v_add_f32_dpp v179, v179, v179 row_ror:1 row_mask:0xf bank_mask:0xf
    v_dot2c_f32_bf16 v234, s24, v45
    v_add_f32_dpp v177, v177, v177 row_ror:2 row_mask:0xf bank_mask:0xf
    v_add_f32_dpp v179, v179, v179 row_ror:2 row_mask:0xf bank_mask:0xf
    v_dot2c_f32_bf16 v235, s25, v45
    v_add_f32_dpp v177, v177, v177 row_ror:4 row_mask:0xf bank_mask:0xf
    v_add_f32_dpp v179, v179, v179 row_ror:4 row_mask:0xf bank_mask:0xf
    v_dot2c_f32_bf16 v236, s24, v46
    v_add_f32_dpp v177, v177, v177 row_ror:8 row_mask:0xf bank_mask:0xf
    v_add_f32_dpp v179, v179, v179 row_ror:8 row_mask:0xf bank_mask:0xf
    v_dot2c_f32_bf16 v237, s25, v46
    v_mul_f32 v2, 0xbb124925, v177
    v_mul_f32 v179, 0x3b124925, v179
    v_fma_f32 v179, -v2, v2, v179
    v_rsq_f32 v181, v179
    v_cvt_pk_bf16_f32 v2, 0, v2
    v_mul_f32 v177, s26, v2
    v_dot2c_f32_bf16 v238, s24, v47
    v_dot2c_f32_bf16 v239, s25, v47
    v_mul_f32 v183, v177, v181
    v_pk_fma_f32 v[224:225], v[224:225], v[180:181], v[182:183] op_sel:[0,1,1] op_sel_hi:[1,1,1]
    v_pk_fma_f32 v[226:227], v[226:227], v[180:181], v[182:183] op_sel:[0,1,1] op_sel_hi:[1,1,1]
    v_pk_fma_f32 v[228:229], v[228:229], v[180:181], v[182:183] op_sel:[0,1,1] op_sel_hi:[1,1,1]
    v_pk_fma_f32 v[230:231], v[230:231], v[180:181], v[182:183] op_sel:[0,1,1] op_sel_hi:[1,1,1]
    v_pk_fma_f32 v[232:233], v[232:233], v[180:181], v[182:183] op_sel:[0,1,1] op_sel_hi:[1,1,1]
    v_pk_fma_f32 v[234:235], v[234:235], v[180:181], v[182:183] op_sel:[0,1,1] op_sel_hi:[1,1,1]
    v_pk_fma_f32 v[236:237], v[236:237], v[180:181], v[182:183] op_sel:[0,1,1] op_sel_hi:[1,1,1]
    v_pk_fma_f32 v[238:239], v[238:239], v[180:181], v[182:183] op_sel:[0,1,1] op_sel_hi:[1,1,1]
    v_pk_fma_f32 v[16:17], v[8:9], v[224:225], v[208:209] op_sel_hi:[0,1,1]
    v_pk_fma_f32 v[18:19], v[8:9], v[226:227], v[210:211] op_sel_hi:[0,1,1]
    v_pk_fma_f32 v[20:21], v[8:9], v[228:229], v[212:213] op_sel_hi:[0,1,1]
    v_pk_fma_f32 v[22:23], v[8:9], v[230:231], v[214:215] op_sel_hi:[0,1,1]
    v_pk_fma_f32 v[24:25], v[8:9], v[232:233], v[216:217] op_sel_hi:[0,1,1]
    v_pk_fma_f32 v[26:27], v[8:9], v[234:235], v[218:219] op_sel_hi:[0,1,1]
    v_pk_fma_f32 v[28:29], v[8:9], v[236:237], v[220:221] op_sel_hi:[0,1,1]
    v_pk_fma_f32 v[30:31], v[8:9], v[238:239], v[222:223] op_sel_hi:[0,1,1]
    v_cvt_pk_bf16_f32 v192, v16, v18
    v_cvt_pk_bf16_f32 v193, v20, v22
    v_cvt_pk_bf16_f32 v194, v24, v26
    v_cvt_pk_bf16_f32 v195, v28, v30
    ds_write_b128 v11, v[192:195] offset:0
    v_cvt_pk_bf16_f32 v196, v17, v19
    v_cvt_pk_bf16_f32 v197, v21, v23
    v_cvt_pk_bf16_f32 v198, v25, v27
    v_cvt_pk_bf16_f32 v199, v29, v31
    ds_write_b128 v11, v[196:199] offset:4096
    v_pk_fma_f32 v[32:33], v[8:9], v[208:209], v[224:225] op_sel_hi:[0,1,1] neg_lo:[0,0,1] neg_hi:[0,0,1]
    v_pk_fma_f32 v[34:35], v[8:9], v[210:211], v[226:227] op_sel_hi:[0,1,1] neg_lo:[0,0,1] neg_hi:[0,0,1]
    v_pk_fma_f32 v[36:37], v[8:9], v[212:213], v[228:229] op_sel_hi:[0,1,1] neg_lo:[0,0,1] neg_hi:[0,0,1]
    v_pk_fma_f32 v[38:39], v[8:9], v[214:215], v[230:231] op_sel_hi:[0,1,1] neg_lo:[0,0,1] neg_hi:[0,0,1]
    v_pk_fma_f32 v[40:41], v[8:9], v[216:217], v[232:233] op_sel_hi:[0,1,1] neg_lo:[0,0,1] neg_hi:[0,0,1]
    v_pk_fma_f32 v[42:43], v[8:9], v[218:219], v[234:235] op_sel_hi:[0,1,1] neg_lo:[0,0,1] neg_hi:[0,0,1]
    v_pk_fma_f32 v[44:45], v[8:9], v[220:221], v[236:237] op_sel_hi:[0,1,1] neg_lo:[0,0,1] neg_hi:[0,0,1]
    v_pk_fma_f32 v[46:47], v[8:9], v[222:223], v[238:239] op_sel_hi:[0,1,1] neg_lo:[0,0,1] neg_hi:[0,0,1]
    v_cvt_pk_bf16_f32 v200, v32, v34
    v_cvt_pk_bf16_f32 v201, v36, v38
    v_cvt_pk_bf16_f32 v202, v40, v42
    v_cvt_pk_bf16_f32 v203, v44, v46
    ds_write_b128 v11, v[200:203] offset:8192
    v_cvt_pk_bf16_f32 v204, v33, v35
    v_cvt_pk_bf16_f32 v205, v37, v39
    v_cvt_pk_bf16_f32 v206, v41, v43
    v_cvt_pk_bf16_f32 v207, v45, v47
    ds_write_b128 v11, v[204:207] offset:12288
    s_waitcnt lgkmcnt(0)
    s_barrier
    ds_read_b128 v[16:19], v12 offset:0
    ds_read_b128 v[20:23], v12 offset:4096
    ds_read_b128 v[24:27], v12 offset:8192
    ds_read_b128 v[28:31], v12 offset:12288
    ds_read_b128 v[32:35], v13 offset:1024
    ds_read_b128 v[36:39], v13 offset:5120
    s_add_u32 s29, s29, 1
    v_mov_b32 v200, s29
    v_mov_b32 v201, s29
    v_mov_b32 v202, s29
    v_mov_b32 v203, s29
    v_mov_b32 v204, s29
    v_mov_b32 v205, s29
    v_mov_b32 v206, s29
    v_mov_b32 v207, s29
    s_waitcnt lgkmcnt(5)
    v_mfma_f32_16x16x32_bf16 v[176:179], v[16:19], v[48:51], 0
    ds_read_b128 v[40:43], v13 offset:9216
    s_waitcnt lgkmcnt(5)
    v_mfma_f32_16x16x32_bf16 v[180:183], v[20:23], v[64:67], 0
    ds_read_b128 v[44:47], v13 offset:13312
    s_waitcnt lgkmcnt(5)
    v_mfma_f32_16x16x32_bf16 v[184:187], v[24:27], v[80:83], 0
    ds_read_b128 v[208:211], v12 offset:2048
    s_waitcnt lgkmcnt(5)
    v_mfma_f32_16x16x32_bf16 v[188:191], v[28:31], v[96:99], 0
    ds_read_b128 v[212:215], v12 offset:6144
    s_waitcnt lgkmcnt(5)
    v_mfma_f32_16x16x32_bf16 v[176:179], v[32:35], v[52:55], v[176:179]
    ds_read_b128 v[216:219], v12 offset:10240
    s_waitcnt lgkmcnt(5)
    v_mfma_f32_16x16x32_bf16 v[180:183], v[36:39], v[68:71], v[180:183]
    ds_read_b128 v[220:223], v12 offset:14336
    s_waitcnt lgkmcnt(5)
    v_mfma_f32_16x16x32_bf16 v[184:187], v[40:43], v[84:87], v[184:187]
    ds_read_b64 v[224:225], v13 offset:3072
    s_waitcnt lgkmcnt(5)
    v_mfma_f32_16x16x32_bf16 v[188:191], v[44:47], v[100:103], v[188:191]
    ds_read_b64 v[228:229], v13 offset:7168
    s_waitcnt lgkmcnt(5)
    v_mfma_f32_16x16x32_bf16 v[176:179], v[208:211], v[56:59], v[176:179]
    ds_read_b64 v[232:233], v13 offset:11264
    s_waitcnt lgkmcnt(5)
    v_mfma_f32_16x16x32_bf16 v[180:183], v[212:215], v[72:75], v[180:183]
    ds_read_b64 v[236:237], v13 offset:15360
    s_waitcnt lgkmcnt(5)
    v_mfma_f32_16x16x32_bf16 v[184:187], v[216:219], v[88:91], v[184:187]
    s_waitcnt lgkmcnt(4)
    v_mfma_f32_16x16x32_bf16 v[188:191], v[220:223], v[104:107], v[188:191]
    s_waitcnt lgkmcnt(3)
    v_mfma_f32_16x16x16_bf16 v[176:179], v[224:225], v[60:61], v[176:179]
    s_waitcnt lgkmcnt(2)
    v_mfma_f32_16x16x16_bf16 v[180:183], v[228:229], v[76:77], v[180:183]
    s_waitcnt lgkmcnt(1)
    v_mfma_f32_16x16x16_bf16 v[184:187], v[232:233], v[92:93], v[184:187]
    s_waitcnt lgkmcnt(0)
    v_mfma_f32_16x16x16_bf16 v[188:191], v[236:237], v[108:109], v[188:191]
    s_mov_b32 s38, s34
    s_lshl_b32 s37, s31, 2
    s_and_b32 s39, s35, 7
    s_cmp_lg_u32 s30, 0
    s_cbranch_scc1 L_nofix
    v_mfma_f32_16x16x32_bf16 v[192:195], v[24:27], v[48:51], 0
    v_mfma_f32_16x16x32_bf16 v[196:199], v[28:31], v[64:67], 0
    v_mfma_f32_16x16x32_bf16 v[192:195], v[40:43], v[52:55], v[192:195]
    v_mfma_f32_16x16x32_bf16 v[196:199], v[44:47], v[68:71], v[196:199]
    v_mfma_f32_16x16x32_bf16 v[192:195], v[216:219], v[56:59], v[192:195]
    v_mfma_f32_16x16x32_bf16 v[196:199], v[220:223], v[72:75], v[196:199]
    v_mfma_f32_16x16x16_bf16 v[192:195], v[232:233], v[60:61], v[192:195]
    v_mfma_f32_16x16x16_bf16 v[196:199], v[236:237], v[76:77], v[196:199]
    s_mov_b64 exec, 0xffff
    s_nop 5
    v_mov_b32 v188, v192
    v_mov_b32 v184, v196
    s_mov_b64 exec, -1
L_nofix:
    v_pk_add_f32 v[48:49], v[176:177], v[180:181]
    v_pk_add_f32 v[50:51], v[178:179], v[182:183]
    v_pk_add_f32 v[56:57], v[176:177], v[180:181] neg_lo:[0,1] neg_hi:[0,1]
    v_pk_add_f32 v[58:59], v[178:179], v[182:183] neg_lo:[0,1] neg_hi:[0,1]
    v_pk_add_f32 v[52:53], v[184:185], v[188:189]
    v_pk_add_f32 v[54:55], v[186:187], v[190:191]
    v_cvt_pk_bf16_f32 v64, v48, v49
    v_cvt_pk_bf16_f32 v65, v50, v51
    v_cvt_pk_bf16_f32 v66, v52, v53
    v_cvt_pk_bf16_f32 v67, v54, v55
    v_pk_add_f32 v[60:61], v[184:185], v[188:189] neg_lo:[1,0] neg_hi:[1,0]
    v_pk_add_f32 v[62:63], v[186:187], v[190:191] neg_lo:[1,0] neg_hi:[1,0]
    v_mfma_f32_16x16x32_bf16 v[72:75], v[168:171], v[64:67], 0
    v_cvt_pk_bf16_f32 v68, v56, v57
    v_cvt_pk_bf16_f32 v69, v58, v59
    v_mfma_f32_16x16x32_bf16 v[76:79], v[172:175], v[64:67], 0
    v_cvt_pk_bf16_f32 v70, v60, v61
    v_cvt_pk_bf16_f32 v71, v62, v63
    s_nop 1
    v_mfma_f32_16x16x32_bf16 v[80:83], v[168:171], v[68:71], 0
    v_mfma_f32_16x16x32_bf16 v[84:87], v[172:175], v[68:71], 0
    s_mov_b64 exec, s[50:51]
    s_nop 0
    v_cvt_pk_bf16_f32 v200, v72, v76
    v_cvt_pk_bf16_f32 v201, v73, v77
    v_cvt_pk_bf16_f32 v202, v74, v78
    v_cvt_pk_bf16_f32 v203, v75, v79
    s_mov_b64 exec, -1
    buffer_store_dword v200, v10, s[16:19], s57 offen sc1
    buffer_store_dword v201, v10, s[16:19], s98 offen sc1
    buffer_store_dword v202, v10, s[16:19], s99 offen sc1
    buffer_store_dword v203, v10, s[16:19], s100 offen sc1
    s_mov_b64 exec, s[50:51]
    v_cvt_pk_bf16_f32 v204, v80, v84
    v_cvt_pk_bf16_f32 v205, v81, v85
    v_cvt_pk_bf16_f32 v206, v82, v86
    v_cvt_pk_bf16_f32 v207, v83, v87
    s_mov_b64 exec, -1
    buffer_store_dword v204, v6, s[16:19], s57 offen sc1
    buffer_store_dword v205, v6, s[16:19], s98 offen sc1
    buffer_store_dword v206, v6, s[16:19], s99 offen sc1
    buffer_store_dword v207, v6, s[16:19], s100 offen sc1
    s_add_u32 s47, s37, s28
    s_lshl4_add_u32 s44, s47, s38
    v_lshl_add_u32 v144, v4, 9, s44
    s_mul_i32 s45, s39, 56
    v_max_u32 v2, 2, v5
    s_sub_u32 s45, s45, 8
    v_lshl_add_u32 v2, v2, 2, s45
    s_movk_i32 s46, 896
    v_mad_u32_u24 v243, v144, s46, v2
    v_sub_u32 v244, 1491836, v243
    v_sub_u32 v246, 0, v144
    v_and_b32 v246, 0x7ff, v246
    v_sub_u32 v2, 892, v2
    v_mad_u32_u24 v245, v246, s46, v2
    v_and_b32 v2, 3, v0
    v_lshl_add_u32 v144, v2, 7, v144
    v_bfe_i32 v2, v0, 2, 1
    v_xor_b32 v144, v144, v2
    v_sub_u32 v144, v144, v2
    v_and_b32 v246, 127, v144
    v_lshlrev_b32 v246, 8, v246
    v_bfe_u32 v2, v144, 7, 4
    v_lshl_add_u32 v246, v2, 4, v246
    s_mov_b32 s52, 131072
    s_mov_b32 s95, 114688
    s_mov_b32 s96, 229376
    s_mov_b32 s97, 344064
    v_lshlrev_b32 v247, 5, v5
    s_lshl2_add_u32 s53, s33, s28
    s_lshl_b32 s53, s53, 9
    s_add_u32 s53, s53, 65536
    s_mov_b32 s22, s14
    s_mov_b32 s23, 0x20000
    buffer_load_dwordx4 v[160:163], v246, s[16:19], s52 offen sc1
    v_and_b32 v3, 32, v0
    v_mul_u32_u24 v3, 124, v3
    v_lshl_add_u32 v249, v1, 2, v3
    s_lshl2_add_u32 s55, s38, s28
    s_lshl_b32 s55, s55, 7
    s_add_u32 s55, s55, s39
    s_lshl_b32 s55, s55, 7
    buffer_load_dword v152, v243, s[12:15], 0 offen
    s_add_u32 s55, s55, 524288
    s_add_u32 s56, s55, 8192
    s_mov_b32 s92, 0xbfb8aa3b
    v_lshlrev_b32 v241, 4, v1
    v_bfe_u32 v2, v0, 4, 1
    v_lshlrev_b32 v2, 10, v2
    v_lshl_add_u32 v2, v5, 4, v2
    buffer_load_dword v153, v243, s[12:15], s95 offen
    v_bfe_u32 v3, v0, 5, 1
    v_lshl_add_u32 v2, v3, 8, v2
    v_lshrrev_b32 v3, 6, v0
    v_lshl_add_u32 v240, v3, 11, v2
    s_add_u32 s47, s37, s28
    v_lshl_add_u32 v145, v5, 3, s47
    v_cvt_f32_u32 v145, v145
    buffer_load_dword v154, v243, s[12:15], s96 offen
    v_mul_f32 v145, 0xbc000000, v145
    v_lshlrev_b32 v147, 2, v4
    v_cvt_f32_u32 v147, v147
    v_mul_f32 v3, v147, v145
    v_mul_f32 v146, 0x41800000, v145
    v_cos_f32 v148, v145
    v_cos_f32 v150, v146
    buffer_load_dword v155, v243, s[12:15], s97 offen
    v_cos_f32 v128, v3
    v_sin_f32 v129, v3
    v_add_f32 v2, v3, v146
    v_cos_f32 v136, v2
    v_sin_f32 v137, v2
    v_add_f32 v3, v3, v145
    v_cos_f32 v130, v3
    buffer_load_dword v156, v245, s[12:15], 0 offen
    v_sin_f32 v131, v3
    v_add_f32 v2, v3, v146
    v_cos_f32 v138, v2
    v_sin_f32 v139, v2
    v_add_f32 v148, v148, v148
    v_add_f32 v150, v150, v150
    v_pk_fma_f32 v[132:133], v[148:149], v[130:131], v[128:129] op_sel_hi:[0,1,1] neg_lo:[0,0,1] neg_hi:[0,0,1]
    buffer_load_dword v157, v244, s[12:15], s96 offen
    v_pk_fma_f32 v[140:141], v[148:149], v[138:139], v[136:137] op_sel_hi:[0,1,1] neg_lo:[0,0,1] neg_hi:[0,0,1]
    v_pk_fma_f32 v[134:135], v[148:149], v[132:133], v[130:131] op_sel_hi:[0,1,1] neg_lo:[0,0,1] neg_hi:[0,0,1]
    v_pk_fma_f32 v[142:143], v[148:149], v[140:141], v[138:139] op_sel_hi:[0,1,1] neg_lo:[0,0,1] neg_hi:[0,0,1]
    v_cvt_pk_bf16_f32 v112, v128, v129
    v_cvt_pk_bf16_f32 v113, v130, v131
    v_cvt_pk_bf16_f32 v114, v132, v133
    v_cvt_pk_bf16_f32 v115, v134, v135
    buffer_load_dword v158, v244, s[12:15], s95 offen
    v_cvt_pk_bf16_f32 v116, v136, v137
    v_cvt_pk_bf16_f32 v117, v138, v139
    v_cvt_pk_bf16_f32 v118, v140, v141
    v_cvt_pk_bf16_f32 v119, v142, v143
    v_pk_fma_f32 v[128:129], v[150:151], v[136:137], v[128:129] op_sel_hi:[0,1,1] neg_lo:[0,0,1] neg_hi:[0,0,1]
    v_pk_fma_f32 v[130:131], v[150:151], v[138:139], v[130:131] op_sel_hi:[0,1,1] neg_lo:[0,0,1] neg_hi:[0,0,1]
    v_pk_fma_f32 v[132:133], v[150:151], v[140:141], v[132:133] op_sel_hi:[0,1,1] neg_lo:[0,0,1] neg_hi:[0,0,1]
    buffer_load_dword v159, v244, s[12:15], 0 offen
    v_pk_fma_f32 v[134:135], v[150:151], v[142:143], v[134:135] op_sel_hi:[0,1,1] neg_lo:[0,0,1] neg_hi:[0,0,1]
    v_cvt_pk_bf16_f32 v120, v128, v129
    v_cvt_pk_bf16_f32 v121, v130, v131
    v_cvt_pk_bf16_f32 v122, v132, v133
    v_cvt_pk_bf16_f32 v123, v134, v135
    v_pk_fma_f32 v[136:137], v[150:151], v[128:129], v[136:137] op_sel_hi:[0,1,1] neg_lo:[0,0,1] neg_hi:[0,0,1]
    v_pk_fma_f32 v[138:139], v[150:151], v[130:131], v[138:139] op_sel_hi:[0,1,1] neg_lo:[0,0,1] neg_hi:[0,0,1]
    v_pk_fma_f32 v[140:141], v[150:151], v[132:133], v[140:141] op_sel_hi:[0,1,1] neg_lo:[0,0,1] neg_hi:[0,0,1]
    v_pk_fma_f32 v[142:143], v[150:151], v[134:135], v[142:143] op_sel_hi:[0,1,1] neg_lo:[0,0,1] neg_hi:[0,0,1]
    v_cvt_pk_bf16_f32 v124, v136, v137
    v_cvt_pk_bf16_f32 v125, v138, v139
    v_cvt_pk_bf16_f32 v126, v140, v141
    v_cvt_pk_bf16_f32 v127, v142, v143
    s_lshl_b32 s44, s28, 31
    s_or_b32 s44, s44, s43
    s_mov_b64 exec, 0xffff
    v_mov_b32 v112, s44
    s_mov_b64 exec, -1
    s_and_b32 s46, s28, 1
    s_mul_i32 s8, s39, 7
    s_sub_u32 s49, 105, s8
    s_cmp_ge_u32 s28, 2
    s_cselect_b32 s8, s49, s8
    s_add_u32 s8, s46, s8
    s_mul_i32 s49, s8, 147
    s_lshr_b32 s49, s49, 12
    s_mul_i32 s4, s49, 224
    s_lshl3_add_u32 s4, s8, s4
    s_bitcmp1_b32 s8, 0
    s_cselect_b32 s49, 216, 0
    s_add_u32 s4, s4, s49
    s_add_u32 s4, s4, 262144
    s_add_u32 s5, s4, 28672
    s_add_u32 s6, s4, 57344
    s_add_u32 s7, s4, 86016
    v_lshrrev_b32 v2, 2, v1
    v_mul_u32_u24 v2, 1792, v2
    v_and_b32 v13, 3, v0
    s_sub_u32 s49, 3, s46
    v_min_u32 v13, s49, v13
    v_lshl_add_u32 v248, v13, 4, v2
    v_mov_b32 v236, 0
    v_mov_b32 v237, 0
    v_mov_b32 v238, s29
    v_lshl_add_u32 v13, v13, 3, v4
    v_lshlrev_b32 v12, 1, v13
    s_lshl_b32 s10, s8, 3
    s_waitcnt vmcnt(0)
    v_mov_b32 v3, 0
    s_branch L_psc1
L_ps1:
    buffer_load_dwordx4 v[160:163], v246, s[16:19], s52 offen sc1
    s_add_u32 s41, s41, 1
    s_cmp_gt_u32 s41, 65536
    s_cbranch_scc1 L_psd1
    s_waitcnt vmcnt(0)
L_psc1:
    v_cmp_ne_u32 vcc, s29, v163
    s_cbranch_vccnz L_ps1
L_psd1:
    s_mov_b64 exec, 0xffff
    buffer_load_dwordx2 v[164:165], v247, s[16:19], s53 offen sc1
    s_mov_b64 exec, -1
    v_mov_b32_dpp v96, v160 row_newbcast:0 row_mask:0xf bank_mask:0xf
    v_mov_b32_dpp v100, v161 row_newbcast:0 row_mask:0xf bank_mask:0xf
    v_mov_b32_dpp v97, v160 row_newbcast:1 row_mask:0xf bank_mask:0xf
    v_mov_b32_dpp v101, v161 row_newbcast:1 row_mask:0xf bank_mask:0xf
    v_and_b32 v128, s32, v152
    v_lshlrev_b32 v132, 16, v152
    v_and_b32 v129, s32, v153
    v_lshlrev_b32 v133, 16, v153
    v_pk_fma_f32 v[24:25], v[128:129], v[96:97], v[100:101]
    v_exp_f32 v192, v24
    v_exp_f32 v193, v25
    buffer_load_dword v176, v249, s[16:19], s55 offen offset:0 sc1
    v_pk_add_f32 v[192:193], v[192:193], 1.0 op_sel_hi:[1,0]
    v_rcp_f32 v192, v192
    v_rcp_f32 v193, v193
    buffer_load_dword v177, v249, s[16:19], s55 offen offset:1024 sc1
    buffer_load_dword v178, v249, s[16:19], s55 offen offset:2048 sc1
    v_pk_fma_f32 v[28:29], v[132:133], v[96:97], v[100:101]
    v_exp_f32 v194, v28
    v_exp_f32 v195, v29
    buffer_load_dword v179, v249, s[16:19], s55 offen offset:3072 sc1
    v_pk_mul_f32 v[24:25], v[24:25], v[192:193]
    v_pk_add_f32 v[194:195], v[194:195], 1.0 op_sel_hi:[1,0]
    v_rcp_f32 v194, v194
    v_rcp_f32 v195, v195
    buffer_load_dword v180, v249, s[16:19], s56 offen offset:0 sc1
    buffer_load_dword v181, v249, s[16:19], s56 offen offset:1024 sc1
    v_mov_b32_dpp v98, v160 row_newbcast:2 row_mask:0xf bank_mask:0xf
    v_mov_b32_dpp v102, v161 row_newbcast:2 row_mask:0xf bank_mask:0xf
    v_mov_b32_dpp v99, v160 row_newbcast:3 row_mask:0xf bank_mask:0xf
    v_mov_b32_dpp v103, v161 row_newbcast:3 row_mask:0xf bank_mask:0xf
    v_and_b32 v130, s32, v154
    v_lshlrev_b32 v134, 16, v154
    v_and_b32 v131, s32, v155
    v_lshlrev_b32 v135, 16, v155
    v_pk_fma_f32 v[26:27], v[130:131], v[98:99], v[102:103]
    v_exp_f32 v192, v26
    v_exp_f32 v193, v27
    buffer_load_dword v182, v249, s[16:19], s56 offen offset:2048 sc1
    v_pk_mul_f32 v[28:29], v[28:29], v[194:195]
    v_pk_add_f32 v[192:193], v[192:193], 1.0 op_sel_hi:[1,0]
    v_rcp_f32 v192, v192
    v_rcp_f32 v193, v193
    buffer_load_dword v183, v249, s[16:19], s56 offen offset:3072 sc1
    v_pk_fma_f32 v[30:31], v[134:135], v[98:99], v[102:103]
    v_exp_f32 v194, v30
    v_exp_f32 v195, v31
    v_pk_mul_f32 v[26:27], v[26:27], v[192:193]
    v_pk_add_f32 v[194:195], v[194:195], 1.0 op_sel_hi:[1,0]
    v_rcp_f32 v194, v194
    v_rcp_f32 v195, v195
    v_mov_b32_dpp v104, v160 row_newbcast:4 row_mask:0xf bank_mask:0xf
    v_mov_b32_dpp v108, v161 row_newbcast:4 row_mask:0xf bank_mask:0xf
    v_mov_b32_dpp v105, v160 row_newbcast:5 row_mask:0xf bank_mask:0xf
    v_mov_b32_dpp v109, v161 row_newbcast:5 row_mask:0xf bank_mask:0xf
    v_and_b32 v136, s32, v156
    v_lshlrev_b32 v140, 16, v156
    v_and_b32 v137, s32, v157
    v_lshlrev_b32 v141, 16, v157
    v_pk_fma_f32 v[32:33], v[136:137], v[104:105], v[108:109]
    v_exp_f32 v192, v32
    v_exp_f32 v193, v33
    v_pk_mul_f32 v[30:31], v[30:31], v[194:195]
    v_pk_add_f32 v[192:193], v[192:193], 1.0 op_sel_hi:[1,0]
    v_rcp_f32 v192, v192
    v_rcp_f32 v193, v193
    v_pk_fma_f32 v[36:37], v[140:141], v[104:105], v[108:109]
    v_exp_f32 v194, v36
    v_exp_f32 v195, v37
    v_pk_mul_f32 v[32:33], v[32:33], v[192:193]
    v_pk_add_f32 v[194:195], v[194:195], 1.0 op_sel_hi:[1,0]
    v_rcp_f32 v194, v194
    v_rcp_f32 v195, v195
    v_mov_b32_dpp v106, v160 row_newbcast:6 row_mask:0xf bank_mask:0xf
    v_mov_b32_dpp v110, v161 row_newbcast:6 row_mask:0xf bank_mask:0xf
    v_mov_b32_dpp v107, v160 row_newbcast:7 row_mask:0xf bank_mask:0xf
    v_mov_b32_dpp v111, v161 row_newbcast:7 row_mask:0xf bank_mask:0xf
    v_and_b32 v138, s32, v158
    v_lshlrev_b32 v142, 16, v158
    v_and_b32 v139, s32, v159
    v_lshlrev_b32 v143, 16, v159
    v_pk_fma_f32 v[34:35], v[138:139], v[106:107], v[110:111]
    v_exp_f32 v192, v34
    v_exp_f32 v193, v35
    v_pk_mul_f32 v[36:37], v[36:37], v[194:195]
    v_pk_add_f32 v[192:193], v[192:193], 1.0 op_sel_hi:[1,0]
    v_rcp_f32 v192, v192
    v_rcp_f32 v193, v193
    v_pk_fma_f32 v[38:39], v[142:143], v[106:107], v[110:111]
    v_exp_f32 v194, v38
    v_exp_f32 v195, v39
    v_pk_mul_f32 v[34:35], v[34:35], v[192:193]
    v_pk_add_f32 v[194:195], v[194:195], 1.0 op_sel_hi:[1,0]
    v_rcp_f32 v194, v194
    v_rcp_f32 v195, v195
    s_nop 0
    v_pk_mul_f32 v[38:39], v[38:39], v[194:195]
    s_branch L_pgc1
L_pg1:
    s_mov_b64 exec, 0xffff
    buffer_load_dwordx2 v[164:165], v247, s[16:19], s53 offen sc1
    s_mov_b64 exec, -1
    buffer_load_dword v176, v249, s[16:19], s55 offen offset:0 sc1
    buffer_load_dword v177, v249, s[16:19], s55 offen offset:1024 sc1
    buffer_load_dword v178, v249, s[16:19], s55 offen offset:2048 sc1
    buffer_load_dword v179, v249, s[16:19], s55 offen offset:3072 sc1
    buffer_load_dword v180, v249, s[16:19], s56 offen offset:0 sc1
    buffer_load_dword v181, v249, s[16:19], s56 offen offset:1024 sc1
    buffer_load_dword v182, v249, s[16:19], s56 offen offset:2048 sc1
    buffer_load_dword v183, v249, s[16:19], s56 offen offset:3072 sc1
    s_add_u32 s41, s41, 1
    s_cmp_gt_u32 s41, 65536
    s_cbranch_scc1 L_pgd1
L_pgc1:
    s_waitcnt vmcnt(8)
    v_cmp_ne_u32 vcc, s29, v165
    s_and_b32 s44, vcc_lo, 0xffff
    s_andn2_b64 exec, 0xffff, vcc
    ds_max_u32 v3, v164 offset:16388
    s_mov_b64 exec, -1
    s_waitcnt vmcnt(4)
    ds_write_b128 v240, v[176:179] offset:18432
    v_bitop3_b32 v2, v176, v177, s29 bitop3:0x7e
    v_bitop3_b32 v8, v178, v179, s29 bitop3:0x7e
    s_waitcnt vmcnt(2)
    v_bitop3_b32 v9, v180, v181, s29 bitop3:0x7e
    v_or3_b32 v2, v2, v8, v9
    s_waitcnt vmcnt(0)
    ds_write_b128 v240, v[180:183] offset:18944
    v_bitop3_b32 v10, v182, v183, s29 bitop3:0x7e
    v_or_b32 v2, v2, v10
    v_cmp_ne_u32 vcc, 0, v2
    s_or_b32 vcc_lo, vcc_lo, vcc_hi
    s_and_b32 vcc_lo, vcc_lo, 0x00010001
    s_or_b32 vcc_lo, vcc_lo, s44
    s_cbranch_scc0 L_pgd1
    s_waitcnt lgkmcnt(0)
    s_branch L_pg1
L_pgd1:
    s_waitcnt lgkmcnt(0)
    s_barrier
    ds_read_b128 v[192:195], v241 offset:18432
    ds_read_b128 v[196:199], v241 offset:19456
    ds_read_b128 v[200:203], v241 offset:20480
    ds_read_b128 v[204:207], v241 offset:21504
    ds_read_b128 v[208:211], v241 offset:22528
    ds_read_b128 v[212:215], v241 offset:23552
    ds_read_b128 v[216:219], v241 offset:24576
    ds_read_b128 v[220:223], v241 offset:25600
    ds_read_b32 v164, v3 offset:16388
    s_mov_b32 s48, 0xfffcfffc
    s_mov_b32 s49, s48
    s_waitcnt lgkmcnt(8)
    v_mfma_f32_16x16x32_bf16 v[16:19], v[112:115], v[192:195], 0
    s_waitcnt lgkmcnt(7)
    v_mfma_f32_16x16x32_bf16 v[20:23], v[112:115], v[196:199], 0
    s_waitcnt lgkmcnt(6)
    v_mfma_f32_16x16x32_bf16 v[16:19], v[116:119], v[200:203], v[16:19]
    s_waitcnt lgkmcnt(5)
    v_mfma_f32_16x16x32_bf16 v[20:23], v[116:119], v[204:207], v[20:23]
    s_waitcnt lgkmcnt(4)
    v_mfma_f32_16x16x32_bf16 v[16:19], v[120:123], v[208:211], v[16:19]
    s_waitcnt lgkmcnt(3)
    v_mfma_f32_16x16x32_bf16 v[20:23], v[120:123], v[212:215], v[20:23]
    s_waitcnt lgkmcnt(2)
    v_mfma_f32_16x16x32_bf16 v[16:19], v[124:127], v[216:219], v[16:19]
    s_waitcnt lgkmcnt(1)
    v_mfma_f32_16x16x32_bf16 v[20:23], v[124:127], v[220:223], v[20:23]
    s_waitcnt lgkmcnt(0)
    v_readfirstlane_b32 s42, v164
    s_lshl4_add_u32 s46, s37, s38
    s_andn2_b32 s40, 0x7ff, s42
    s_sub_u32 s47, 0, s40
    s_xor_b32 s44, s40, s46
    s_xor_b32 s45, s47, s46
    s_and_b32 s44, s44, 79
    v_pk_fma_f32 v[32:33], v[16:17], v[32:33], v[136:137]
    v_pk_fma_f32 v[36:37], v[20:21], v[36:37], v[140:141]
    v_cvt_pk_bf16_f32 v156, v36, v32
    v_cvt_pk_bf16_f32 v157, v37, v33
    v_pk_fma_f32 v[34:35], v[18:19], v[34:35], v[138:139]
    v_pk_fma_f32 v[38:39], v[22:23], v[38:39], v[142:143]
    v_cvt_pk_bf16_f32 v158, v38, v34
    v_cvt_pk_bf16_f32 v159, v39, v35
    v_mov_b32_dpp v176, v20 row_shr:1 row_mask:0xf bank_mask:0xf
    v_mov_b32_dpp v177, v21 row_shr:1 row_mask:0xf bank_mask:0xf
    v_mov_b32_dpp v178, v22 row_shr:1 row_mask:0xf bank_mask:0xf
    v_mov_b32_dpp v179, v23 row_shr:1 row_mask:0xf bank_mask:0xf
    s_mov_b64 exec, s[48:49]
    buffer_store_dword v156, v245, s[20:23], 0 offen
    v_pk_fma_f32 v[24:25], v[16:17], v[24:25], v[128:129]
    v_pk_fma_f32 v[28:29], v[176:177], v[28:29], v[132:133]
    buffer_store_dword v157, v244, s[20:23], s96 offen
    v_cvt_pk_bf16_f32 v152, v28, v24
    v_cvt_pk_bf16_f32 v153, v29, v25
    buffer_store_dword v158, v244, s[20:23], s95 offen
    v_pk_fma_f32 v[26:27], v[18:19], v[26:27], v[130:131]
    v_pk_fma_f32 v[30:31], v[178:179], v[30:31], v[134:135]
    buffer_store_dword v159, v244, s[20:23], 0 offen
    v_cvt_pk_bf16_f32 v154, v30, v26
    v_cvt_pk_bf16_f32 v155, v31, v27
    s_and_b32 s45, s45, 79
    s_cmp_ge_u32 s28, 2
    s_cselect_b32 s9, s45, s44
    buffer_store_dword v152, v243, s[20:23], 0 offen
    buffer_store_dword v153, v243, s[20:23], s95 offen
    buffer_store_dword v154, v243, s[20:23], s96 offen
    buffer_store_dword v155, v243, s[20:23], s97 offen
    s_cmp_lg_u32 s9, 0
    s_cbranch_scc1 L_nopl1
    s_mov_b64 exec, -1
    s_mul_i32 s11, s40, 896
    s_add_u32 s10, s10, s11
    buffer_load_ushort v91, v12, s[12:15], s10 offen
    s_and_b32 s11, s40, 127
    s_lshl_b32 s11, s11, 8
    s_lshr_b32 s46, s40, 7
    s_lshl4_add_u32 s11, s46, s11
    s_add_u32 s11, s11, 131072
    buffer_load_dwordx2 v[92:93], off, s[16:19], s11 sc1
L_nopl1:
    s_mov_b64 exec, -1
    s_mul_i32 s46, s44, s45
    s_cmp_lg_u32 s46, 0
    s_cbranch_scc1 L_fin
    v_lshlrev_b32 v2, 5, v5
    s_bfe_u32 s48, s40, 0x20004
    s_cmp_lg_u32 s48, s28
    s_cbranch_scc1 L_norow01
    s_bfe_u32 s48, s40, 0x20009
    v_cmp_eq_u32 vcc, s48, v4
    s_mov_b64 exec, vcc
    ds_write_b128 v2, v[16:19] offset:16896
    ds_write_b128 v2, v[20:23] offset:16912
L_rowd01:
    s_mov_b64 exec, -1
L_norow01:
    s_bfe_u32 s48, s47, 0x20004
    s_cmp_lg_u32 s48, s28
    s_cbranch_scc1 L_norow11
    s_bfe_u32 s48, s47, 0x20009
    v_cmp_eq_u32 vcc, s48, v4
    s_mov_b64 exec, vcc
    ds_write_b128 v2, v[16:19] offset:17408
    ds_write_b128 v2, v[20:23] offset:17424
L_rowd11:
    s_mov_b64 exec, -1
L_norow11:
    s_branch L_owner
L_router:
    s_mov_b32 s38, s33
    s_mov_b32 s37, 0
    s_mov_b32 s39, s35
    s_add_u32 s47, s37, s28
    s_lshl4_add_u32 s44, s47, s38
    v_lshl_add_u32 v144, v4, 9, s44
    s_mul_i32 s45, s39, 56
    v_max_u32 v2, 2, v5
    s_sub_u32 s45, s45, 8
    v_lshl_add_u32 v2, v2, 2, s45
    s_movk_i32 s46, 896
    v_mad_u32_u24 v243, v144, s46, v2
    v_sub_u32 v244, 1491836, v243
    v_sub_u32 v246, 0, v144
    v_and_b32 v246, 0x7ff, v246
    v_sub_u32 v2, 892, v2
    v_mad_u32_u24 v245, v246, s46, v2
    v_and_b32 v2, 3, v0
    v_lshl_add_u32 v144, v2, 7, v144
    v_bfe_u32 v3, v0, 3, 1
    v_lshl_add_u32 v144, v3, 6, v144
    v_add_u32 v251, 57344, v243
    v_subrev_u32 v252, 57344, v244
    s_mov_b32 s32, 0xffff0000
    v_bfe_i32 v2, v0, 2, 1
    v_xor_b32 v144, v144, v2
    v_sub_u32 v144, v144, v2
    v_and_b32 v246, 127, v144
    v_lshlrev_b32 v246, 8, v246
    v_bfe_u32 v2, v144, 7, 4
    v_lshl_add_u32 v246, v2, 4, v246
    s_mov_b32 s52, 131072
    s_mov_b32 s95, 114688
    s_mov_b32 s96, 229376
    s_mov_b32 s97, 344064
    v_lshlrev_b32 v247, 5, v5
    s_lshl2_add_u32 s53, s33, s28
    s_lshl_b32 s53, s53, 9
    s_add_u32 s53, s53, 65536
    s_mov_b32 s22, s14
    s_mov_b32 s23, 0x20000
    v_and_b32 v3, 32, v0
    v_mul_u32_u24 v3, 124, v3
    v_lshl_add_u32 v249, v1, 2, v3
    s_lshl2_add_u32 s55, s38, s28
    s_lshl_b32 s55, s55, 7
    s_add_u32 s55, s55, s39
    s_lshl_b32 s55, s55, 7
    s_add_u32 s55, s55, 524288
    s_add_u32 s56, s55, 8192
    s_mov_b32 s92, 0xbfb8aa3b
    v_lshlrev_b32 v241, 4, v1
    v_bfe_u32 v2, v0, 4, 1
    v_lshlrev_b32 v2, 10, v2
    v_lshl_add_u32 v2, v5, 4, v2
    v_bfe_u32 v3, v0, 5, 1
    v_lshl_add_u32 v2, v3, 8, v2
    v_lshrrev_b32 v3, 6, v0
    v_lshl_add_u32 v240, v3, 11, v2
    v_mov_b32 v2, 0
    v_mov_b32 v3, 0
    ds_write_b64 v3, v[2:3] offset:16384
    s_lshl_b32 s44, s28, 10
    v_add_u32 v15, s44, v15
    v_add_u32 v14, s44, v14
    v_mov_b32 v12, 0
    v_mov_b32 v76, 0
    v_mov_b32 v77, 0x3a12ccf7
    v_mov_b32 v78, 0
    v_lshlrev_b32 v13, 4, v13
    s_lshl_b32 s99, s59, 8
    s_add_u32 s99, s99, 131072
    v_lshlrev_b32 v11, 8, v1
    s_mov_b32 s100, s30
    s_lshl_b32 s100, s100, 5
    s_add_u32 s100, s100, 65536
    v_xor_b32 v6, 0x7ff, v6
    s_waitcnt lgkmcnt(0)
    s_barrier
    s_cmp_eq_u32 s28, 0
    s_cselect_b32 s44, 0, 2.0
    v_or_b32 v2, s44, v11
    s_mov_b32 exec_lo, 0x1010101
    s_mov_b32 exec_hi, 0x1010101
    buffer_store_dword v3, v2, s[16:19], s100 offen offset:8 sc1
    s_mov_b64 exec, -1
    s_waitcnt vmcnt(9)
    ds_write_b128 v15, v[72:75] offset:0
    ds_read_b128 v[44:47], v14 offset:768
    ds_read_b128 v[48:51], v14 offset:640
    ds_read_b128 v[52:55], v14 offset:512
    ds_read_b128 v[56:59], v14 offset:384
    ds_read_b128 v[60:63], v14 offset:256
    ds_read_b128 v[64:67], v14 offset:128
    ds_read_b128 v[68:71], v14 offset:0
    v_dot2c_f32_bf16 v12, s43, v72
    v_dot2c_f32_bf16 v12, s43, v73
    v_dot2c_f32_bf16 v12, s43, v74
    v_dot2c_f32_bf16 v12, s43, v75
    s_waitcnt vmcnt(7)
    v_readfirstlane_b32 s29, v254
    s_add_u32 s29, s29, 1
    v_dot2c_f32_bf16 v76, s43, v16
    v_dot2c_f32_bf16 v77, v16, v16
    v_add_f32_dpp v12, v12, v12 row_shr:1 row_mask:0xf bank_mask:0xf
    v_dot2c_f32_bf16 v76, s43, v17
    v_dot2c_f32_bf16 v77, v17, v17
    v_add_f32_dpp v12, v12, v12 row_shr:2 row_mask:0xf bank_mask:0xf
    v_dot2c_f32_bf16 v76, s43, v18
    v_dot2c_f32_bf16 v77, v18, v18
    v_add_f32_dpp v12, v12, v12 row_shr:4 row_mask:0xf bank_mask:0xf
    v_dot2c_f32_bf16 v76, s43, v19
    v_dot2c_f32_bf16 v77, v19, v19
    v_add_f32_dpp v12, v12, v12 row_shr:8 row_mask:0xf bank_mask:0xf
    s_waitcnt vmcnt(6)
    s_waitcnt lgkmcnt(0)
    v_dot2c_f32_bf16 v76, s43, v20
    v_dot2c_f32_bf16 v77, v20, v20
    v_dot2c_f32_bf16 v78, v44, v16
    v_dot2c_f32_bf16 v78, v48, v20
    v_add_f32_dpp v12, v12, v12 row_bcast:15 row_mask:0xa bank_mask:0xf
    v_dot2c_f32_bf16 v76, s43, v21
    v_dot2c_f32_bf16 v77, v21, v21
    v_dot2c_f32_bf16 v78, v45, v17
    v_dot2c_f32_bf16 v78, v49, v21
    v_add_f32_dpp v12, v12, v12 row_bcast:31 row_mask:0xc bank_mask:0xf
    v_dot2c_f32_bf16 v76, s43, v22
    v_dot2c_f32_bf16 v77, v22, v22
    v_dot2c_f32_bf16 v78, v46, v18
    v_dot2c_f32_bf16 v78, v50, v22
    v_readlane_b32 s3, v12, 63
    v_dot2c_f32_bf16 v76, s43, v23
    v_dot2c_f32_bf16 v77, v23, v23
    v_dot2c_f32_bf16 v78, v47, v19
    v_dot2c_f32_bf16 v78, v51, v23
    s_waitcnt vmcnt(5)
    v_dot2c_f32_bf16 v76, s43, v24
    v_dot2c_f32_bf16 v77, v24, v24
    v_dot2c_f32_bf16 v78, v52, v24
    v_dot2c_f32_bf16 v76, s43, v25
    v_dot2c_f32_bf16 v77, v25, v25
    v_dot2c_f32_bf16 v78, v53, v25
    v_dot2c_f32_bf16 v76, s43, v26
    v_dot2c_f32_bf16 v77, v26, v26
    v_dot2c_f32_bf16 v78, v54, v26
    v_dot2c_f32_bf16 v76, s43, v27
    v_dot2c_f32_bf16 v77, v27, v27
    v_dot2c_f32_bf16 v78, v55, v27
    s_waitcnt vmcnt(4)
    v_dot2c_f32_bf16 v76, s43, v28
    v_dot2c_f32_bf16 v77, v28, v28
    v_dot2c_f32_bf16 v78, v56, v28
    v_dot2c_f32_bf16 v76, s43, v29
    v_dot2c_f32_bf16 v77, v29, v29
    v_dot2c_f32_bf16 v78, v57, v29
    v_dot2c_f32_bf16 v76, s43, v30
    v_dot2c_f32_bf16 v77, v30, v30
    v_dot2c_f32_bf16 v78, v58, v30
    v_dot2c_f32_bf16 v76, s43, v31
    v_dot2c_f32_bf16 v77, v31, v31
    v_dot2c_f32_bf16 v78, v59, v31
    s_waitcnt vmcnt(3)
    v_dot2c_f32_bf16 v76, s43, v32
    v_dot2c_f32_bf16 v77, v32, v32
    v_dot2c_f32_bf16 v78, v60, v32
    v_dot2c_f32_bf16 v76, s43, v33
    v_dot2c_f32_bf16 v77, v33, v33
    v_dot2c_f32_bf16 v78, v61, v33
    v_dot2c_f32_bf16 v76, s43, v34
    v_dot2c_f32_bf16 v77, v34, v34
    v_dot2c_f32_bf16 v78, v62, v34
    v_dot2c_f32_bf16 v76, s43, v35
    v_dot2c_f32_bf16 v77, v35, v35
    v_dot2c_f32_bf16 v78, v63, v35
    s_waitcnt vmcnt(2)
    v_dot2c_f32_bf16 v76, s43, v36
    v_dot2c_f32_bf16 v77, v36, v36
    v_dot2c_f32_bf16 v78, v64, v36
    v_dot2c_f32_bf16 v76, s43, v37
    v_dot2c_f32_bf16 v77, v37, v37
    v_dot2c_f32_bf16 v78, v65, v37
    v_dot2c_f32_bf16 v76, s43, v38
    v_dot2c_f32_bf16 v77, v38, v38
    v_dot2c_f32_bf16 v78, v66, v38
    v_dot2c_f32_bf16 v76, s43, v39
    v_dot2c_f32_bf16 v77, v39, v39
    v_dot2c_f32_bf16 v78, v67, v39
    s_waitcnt vmcnt(1)
    v_dot2c_f32_bf16 v76, s43, v40
    v_dot2c_f32_bf16 v77, v40, v40
    v_dot2c_f32_bf16 v78, v68, v40
    v_dot2c_f32_bf16 v76, s43, v41
    v_dot2c_f32_bf16 v77, v41, v41
    v_dot2c_f32_bf16 v78, v69, v41
    v_dot2c_f32_bf16 v76, s43, v42
    v_dot2c_f32_bf16 v77, v42, v42
    v_dot2c_f32_bf16 v78, v70, v42
    v_dot2c_f32_bf16 v76, s43, v43
    v_dot2c_f32_bf16 v77, v43, v43
    v_dot2c_f32_bf16 v78, v71, v43
    v_mov_b32 v83, s29
    v_add_f32_dpp v76, v76, v76 quad_perm:[1,0,3,2] row_mask:0xf bank_mask:0xf
    v_add_f32_dpp v77, v77, v77 quad_perm:[1,0,3,2] row_mask:0xf bank_mask:0xf
    v_add_f32_dpp v78, v78, v78 quad_perm:[1,0,3,2] row_mask:0xf bank_mask:0xf
    v_add_f32_dpp v76, v76, v76 quad_perm:[2,3,0,1] row_mask:0xf bank_mask:0xf
    v_add_f32_dpp v77, v77, v77 quad_perm:[2,3,0,1] row_mask:0xf bank_mask:0xf
    v_add_f32_dpp v78, v78, v78 quad_perm:[2,3,0,1] row_mask:0xf bank_mask:0xf
    v_add_f32_dpp v76, v76, v76 row_half_mirror row_mask:0xf bank_mask:0xf
    v_add_f32_dpp v77, v77, v77 row_half_mirror row_mask:0xf bank_mask:0xf
    v_add_f32_dpp v78, v78, v78 row_half_mirror row_mask:0xf bank_mask:0xf
    v_mul_f32 v82, 0xbb124925, v76
    v_mul_f32 v2, 0x3b124925, v77
    v_fma_f32 v2, -v82, v82, v2
    v_rsq_f32 v80, v2
    v_cvt_pk_bf16_f32 v82, 0, v82
    v_fmac_f32 v78, s3, v82
    v_mul_f32 v78, v78, v80
    s_movk_i32 s44, 0x7ff
    v_ashrrev_i32 v2, 31, v78
    v_or_b32 v2, 0x80000000, v2
    v_xor_b32 v2, v2, v78
    s_mov_b32 exec_lo, 0x1010101
    s_mov_b32 exec_hi, 0x1010101
    v_bfi_b32 v2, s44, v6, v2
    ds_max_u32 v3, v2 offset:16384
    v_mul_f32 v80, s92, v80
    v_mul_f32 v81, v82, v80
    v_mov_b32 v79, s29
    s_cmp_lg_u32 s28, 0
    s_waitcnt lgkmcnt(0)
    s_barrier
    s_cbranch_scc1 L_nokey
    ds_read_b32 v78, v3 offset:16384
    s_waitcnt lgkmcnt(0)
    buffer_store_dwordx2 v[78:79], v11, s[16:19], s100 offen sc1
L_nokey:
    buffer_store_dwordx4 v[80:83], v13, s[16:19], s99 offen sc1
    s_mov_b64 exec, -1
    s_add_u32 s47, s37, s28
    v_lshl_add_u32 v145, v5, 3, s47
    v_cvt_f32_u32 v145, v145
    v_mul_f32 v145, 0xbc000000, v145
    v_lshlrev_b32 v147, 2, v4
    v_cvt_f32_u32 v147, v147
    v_mul_f32 v3, v147, v145
    buffer_load_dword v160, v243, s[12:15], 0 offen
    v_mul_f32 v146, 0x41800000, v145
    v_cos_f32 v148, v145
    v_cos_f32 v150, v146
    v_cos_f32 v128, v3
    v_sin_f32 v129, v3
    v_add_f32 v2, v3, v146
    v_cos_f32 v136, v2
    v_sin_f32 v137, v2
    buffer_load_dword v161, v243, s[12:15], s95 offen
    v_add_f32 v3, v3, v145
    v_cos_f32 v130, v3
    v_sin_f32 v131, v3
    v_add_f32 v2, v3, v146
    v_cos_f32 v138, v2
    v_sin_f32 v139, v2
    v_add_f32 v148, v148, v148
    v_add_f32 v150, v150, v150
    buffer_load_dword v162, v243, s[12:15], s96 offen
    v_pk_fma_f32 v[132:133], v[148:149], v[130:131], v[128:129] op_sel_hi:[0,1,1] neg_lo:[0,0,1] neg_hi:[0,0,1]
    v_pk_fma_f32 v[140:141], v[148:149], v[138:139], v[136:137] op_sel_hi:[0,1,1] neg_lo:[0,0,1] neg_hi:[0,0,1]
    v_pk_fma_f32 v[134:135], v[148:149], v[132:133], v[130:131] op_sel_hi:[0,1,1] neg_lo:[0,0,1] neg_hi:[0,0,1]
    v_pk_fma_f32 v[142:143], v[148:149], v[140:141], v[138:139] op_sel_hi:[0,1,1] neg_lo:[0,0,1] neg_hi:[0,0,1]
    v_cvt_pk_bf16_f32 v96, v128, v129
    v_cvt_pk_bf16_f32 v97, v130, v131
    v_cvt_pk_bf16_f32 v98, v132, v133
    v_cvt_pk_bf16_f32 v99, v134, v135
    buffer_load_dword v163, v243, s[12:15], s97 offen
    v_cvt_pk_bf16_f32 v100, v136, v137
    v_cvt_pk_bf16_f32 v101, v138, v139
    v_cvt_pk_bf16_f32 v102, v140, v141
    v_cvt_pk_bf16_f32 v103, v142, v143
    v_pk_fma_f32 v[128:129], v[150:151], v[136:137], v[128:129] op_sel_hi:[0,1,1] neg_lo:[0,0,1] neg_hi:[0,0,1]
    v_pk_fma_f32 v[130:131], v[150:151], v[138:139], v[130:131] op_sel_hi:[0,1,1] neg_lo:[0,0,1] neg_hi:[0,0,1]
    v_pk_fma_f32 v[132:133], v[150:151], v[140:141], v[132:133] op_sel_hi:[0,1,1] neg_lo:[0,0,1] neg_hi:[0,0,1]
    v_pk_fma_f32 v[134:135], v[150:151], v[142:143], v[134:135] op_sel_hi:[0,1,1] neg_lo:[0,0,1] neg_hi:[0,0,1]
    buffer_load_dword v164, v245, s[12:15], 0 offen
    v_cvt_pk_bf16_f32 v104, v128, v129
    v_cvt_pk_bf16_f32 v105, v130, v131
    v_cvt_pk_bf16_f32 v106, v132, v133
    v_cvt_pk_bf16_f32 v107, v134, v135
    v_pk_fma_f32 v[136:137], v[150:151], v[128:129], v[136:137] op_sel_hi:[0,1,1] neg_lo:[0,0,1] neg_hi:[0,0,1]
    v_pk_fma_f32 v[138:139], v[150:151], v[130:131], v[138:139] op_sel_hi:[0,1,1] neg_lo:[0,0,1] neg_hi:[0,0,1]
    v_pk_fma_f32 v[140:141], v[150:151], v[132:133], v[140:141] op_sel_hi:[0,1,1] neg_lo:[0,0,1] neg_hi:[0,0,1]
    v_pk_fma_f32 v[142:143], v[150:151], v[134:135], v[142:143] op_sel_hi:[0,1,1] neg_lo:[0,0,1] neg_hi:[0,0,1]
    buffer_load_dword v165, v244, s[12:15], s96 offen
    v_cvt_pk_bf16_f32 v108, v136, v137
    v_cvt_pk_bf16_f32 v109, v138, v139
    v_cvt_pk_bf16_f32 v110, v140, v141
    v_cvt_pk_bf16_f32 v111, v142, v143
    v_add_f32 v145, 0xbd000000, v145
    v_mul_f32 v3, v147, v145
    v_mul_f32 v146, 0x41800000, v145
    v_cos_f32 v148, v145
    buffer_load_dword v166, v244, s[12:15], s95 offen
    v_cos_f32 v150, v146
    v_cos_f32 v128, v3
    v_sin_f32 v129, v3
    v_add_f32 v2, v3, v146
    v_cos_f32 v136, v2
    v_sin_f32 v137, v2
    v_add_f32 v3, v3, v145
    v_cos_f32 v130, v3
    buffer_load_dword v167, v244, s[12:15], 0 offen
    v_sin_f32 v131, v3
    v_add_f32 v2, v3, v146
    v_cos_f32 v138, v2
    v_sin_f32 v139, v2
    v_add_f32 v148, v148, v148
    v_add_f32 v150, v150, v150
    v_pk_fma_f32 v[132:133], v[148:149], v[130:131], v[128:129] op_sel_hi:[0,1,1] neg_lo:[0,0,1] neg_hi:[0,0,1]
    v_pk_fma_f32 v[140:141], v[148:149], v[138:139], v[136:137] op_sel_hi:[0,1,1] neg_lo:[0,0,1] neg_hi:[0,0,1]
    buffer_load_dword v168, v251, s[12:15], 0 offen
    v_pk_fma_f32 v[134:135], v[148:149], v[132:133], v[130:131] op_sel_hi:[0,1,1] neg_lo:[0,0,1] neg_hi:[0,0,1]
    v_pk_fma_f32 v[142:143], v[148:149], v[140:141], v[138:139] op_sel_hi:[0,1,1] neg_lo:[0,0,1] neg_hi:[0,0,1]
    v_cvt_pk_bf16_f32 v112, v128, v129
    v_cvt_pk_bf16_f32 v113, v130, v131
    v_cvt_pk_bf16_f32 v114, v132, v133
    v_cvt_pk_bf16_f32 v115, v134, v135
    v_cvt_pk_bf16_f32 v116, v136, v137
    v_cvt_pk_bf16_f32 v117, v138, v139
    buffer_load_dword v169, v251, s[12:15], s95 offen
    v_cvt_pk_bf16_f32 v118, v140, v141
    v_cvt_pk_bf16_f32 v119, v142, v143
    v_pk_fma_f32 v[128:129], v[150:151], v[136:137], v[128:129] op_sel_hi:[0,1,1] neg_lo:[0,0,1] neg_hi:[0,0,1]
    v_pk_fma_f32 v[130:131], v[150:151], v[138:139], v[130:131] op_sel_hi:[0,1,1] neg_lo:[0,0,1] neg_hi:[0,0,1]
    v_pk_fma_f32 v[132:133], v[150:151], v[140:141], v[132:133] op_sel_hi:[0,1,1] neg_lo:[0,0,1] neg_hi:[0,0,1]
    v_pk_fma_f32 v[134:135], v[150:151], v[142:143], v[134:135] op_sel_hi:[0,1,1] neg_lo:[0,0,1] neg_hi:[0,0,1]
    v_cvt_pk_bf16_f32 v120, v128, v129
    v_cvt_pk_bf16_f32 v121, v130, v131
    buffer_load_dword v170, v251, s[12:15], s96 offen
    v_cvt_pk_bf16_f32 v122, v132, v133
    v_cvt_pk_bf16_f32 v123, v134, v135
    v_pk_fma_f32 v[136:137], v[150:151], v[128:129], v[136:137] op_sel_hi:[0,1,1] neg_lo:[0,0,1] neg_hi:[0,0,1]
    v_pk_fma_f32 v[138:139], v[150:151], v[130:131], v[138:139] op_sel_hi:[0,1,1] neg_lo:[0,0,1] neg_hi:[0,0,1]
    v_pk_fma_f32 v[140:141], v[150:151], v[132:133], v[140:141] op_sel_hi:[0,1,1] neg_lo:[0,0,1] neg_hi:[0,0,1]
    v_pk_fma_f32 v[142:143], v[150:151], v[134:135], v[142:143] op_sel_hi:[0,1,1] neg_lo:[0,0,1] neg_hi:[0,0,1]
    v_cvt_pk_bf16_f32 v124, v136, v137
    v_cvt_pk_bf16_f32 v125, v138, v139
    buffer_load_dword v171, v251, s[12:15], s97 offen
    v_cvt_pk_bf16_f32 v126, v140, v141
    v_cvt_pk_bf16_f32 v127, v142, v143
    s_lshl_b32 s44, s28, 31
    s_or_b32 s44, s44, s43
    s_mov_b64 exec, 0xffff
    v_mov_b32 v96, s44
    v_mov_b32 v112, s44
    s_mov_b64 exec, -1
    buffer_load_dword v172, v252, s[12:15], s97 offen
    buffer_load_dword v173, v252, s[12:15], s96 offen
    buffer_load_dword v174, v252, s[12:15], s95 offen
    buffer_load_dword v175, v252, s[12:15], 0 offen
    buffer_load_dwordx4 v[84:87], v246, s[16:19], s52 offen sc1
    s_and_b32 s46, s28, 1
    s_mul_i32 s8, s39, 7
    s_sub_u32 s49, 105, s8
    s_cmp_ge_u32 s28, 2
    s_cselect_b32 s8, s49, s8
    s_add_u32 s8, s46, s8
    s_mul_i32 s49, s8, 147
    s_lshr_b32 s49, s49, 12
    s_mul_i32 s4, s49, 224
    s_lshl3_add_u32 s4, s8, s4
    s_bitcmp1_b32 s8, 0
    s_cselect_b32 s49, 216, 0
    s_add_u32 s4, s4, s49
    s_add_u32 s4, s4, 262144
    s_add_u32 s5, s4, 28672
    s_add_u32 s6, s4, 57344
    s_add_u32 s7, s4, 86016
    v_lshrrev_b32 v2, 2, v1
    v_mul_u32_u24 v2, 1792, v2
    v_and_b32 v13, 3, v0
    s_sub_u32 s49, 3, s46
    v_min_u32 v13, s49, v13
    v_lshl_add_u32 v248, v13, 4, v2
    v_mov_b32 v236, 0
    v_mov_b32 v237, 0
    v_mov_b32 v238, s29
    v_lshl_add_u32 v13, v13, 3, v4
    v_lshlrev_b32 v12, 1, v13
    s_lshl_b32 s10, s8, 3
    s_waitcnt vmcnt(1)
    v_and_b32 v128, s32, v160
    v_lshlrev_b32 v132, 16, v160
    v_and_b32 v129, s32, v161
    v_lshlrev_b32 v133, 16, v161
    v_and_b32 v130, s32, v162
    v_lshlrev_b32 v134, 16, v162
    v_and_b32 v131, s32, v163
    v_lshlrev_b32 v135, 16, v163
    v_and_b32 v136, s32, v164
    v_lshlrev_b32 v140, 16, v164
    v_and_b32 v137, s32, v165
    v_lshlrev_b32 v141, 16, v165
    v_and_b32 v138, s32, v166
    v_lshlrev_b32 v142, 16, v166
    v_and_b32 v139, s32, v167
    v_lshlrev_b32 v143, 16, v167
    v_and_b32 v144, s32, v168
    v_lshlrev_b32 v148, 16, v168
    v_and_b32 v145, s32, v169
    v_lshlrev_b32 v149, 16, v169
    v_and_b32 v146, s32, v170
    v_lshlrev_b32 v150, 16, v170
    v_and_b32 v147, s32, v171
    v_lshlrev_b32 v151, 16, v171
    v_and_b32 v152, s32, v172
    v_lshlrev_b32 v156, 16, v172
    v_and_b32 v153, s32, v173
    v_lshlrev_b32 v157, 16, v173
    v_and_b32 v154, s32, v174
    v_lshlrev_b32 v158, 16, v174
    v_and_b32 v155, s32, v175
    v_lshlrev_b32 v159, 16, v175
    s_waitcnt vmcnt(0)
    v_mov_b32 v3, 0
    s_branch L_psc2
L_ps2:
    buffer_load_dwordx4 v[84:87], v246, s[16:19], s52 offen sc1
    s_add_u32 s41, s41, 1
    s_cmp_gt_u32 s41, 65536
    s_cbranch_scc1 L_psd2
    s_waitcnt vmcnt(0)
L_psc2:
    v_cmp_ne_u32 vcc, s29, v87
    s_cbranch_vccnz L_ps2
L_psd2:
    v_mov_b32_dpp v176, v84 row_newbcast:0 row_mask:0xf bank_mask:0xf
    v_mov_b32_dpp v180, v85 row_newbcast:0 row_mask:0xf bank_mask:0xf
    v_mov_b32_dpp v177, v84 row_newbcast:1 row_mask:0xf bank_mask:0xf
    v_mov_b32_dpp v181, v85 row_newbcast:1 row_mask:0xf bank_mask:0xf
    v_pk_fma_f32 v[16:17], v[128:129], v[176:177], v[180:181]
    v_exp_f32 v192, v16
    v_exp_f32 v193, v17
    s_nop 0
    v_pk_add_f32 v[192:193], v[192:193], 1.0 op_sel_hi:[1,0]
    v_rcp_f32 v192, v192
    v_rcp_f32 v193, v193
    v_pk_fma_f32 v[20:21], v[132:133], v[176:177], v[180:181]
    v_exp_f32 v194, v20
    v_exp_f32 v195, v21
    v_pk_mul_f32 v[16:17], v[16:17], v[192:193]
    v_pk_add_f32 v[194:195], v[194:195], 1.0 op_sel_hi:[1,0]
    v_rcp_f32 v194, v194
    v_rcp_f32 v195, v195
    v_mov_b32_dpp v178, v84 row_newbcast:2 row_mask:0xf bank_mask:0xf
    v_mov_b32_dpp v182, v85 row_newbcast:2 row_mask:0xf bank_mask:0xf
    v_mov_b32_dpp v179, v84 row_newbcast:3 row_mask:0xf bank_mask:0xf
    v_mov_b32_dpp v183, v85 row_newbcast:3 row_mask:0xf bank_mask:0xf
    v_pk_fma_f32 v[18:19], v[130:131], v[178:179], v[182:183]
    v_exp_f32 v192, v18
    v_exp_f32 v193, v19
    v_pk_mul_f32 v[20:21], v[20:21], v[194:195]
    v_pk_add_f32 v[192:193], v[192:193], 1.0 op_sel_hi:[1,0]
    v_rcp_f32 v192, v192
    v_rcp_f32 v193, v193
    v_pk_fma_f32 v[22:23], v[134:135], v[178:179], v[182:183]
    v_exp_f32 v194, v22
    v_exp_f32 v195, v23
    v_pk_mul_f32 v[18:19], v[18:19], v[192:193]
    v_pk_add_f32 v[194:195], v[194:195], 1.0 op_sel_hi:[1,0]
    v_rcp_f32 v194, v194
    v_rcp_f32 v195, v195
    v_mov_b32_dpp v184, v84 row_newbcast:4 row_mask:0xf bank_mask:0xf
    v_mov_b32_dpp v188, v85 row_newbcast:4 row_mask:0xf bank_mask:0xf
    v_mov_b32_dpp v185, v84 row_newbcast:5 row_mask:0xf bank_mask:0xf
    v_mov_b32_dpp v189, v85 row_newbcast:5 row_mask:0xf bank_mask:0xf
    v_pk_fma_f32 v[24:25], v[136:137], v[184:185], v[188:189]
    v_exp_f32 v192, v24
    v_exp_f32 v193, v25
    v_pk_mul_f32 v[22:23], v[22:23], v[194:195]
    v_pk_add_f32 v[192:193], v[192:193], 1.0 op_sel_hi:[1,0]
    v_rcp_f32 v192, v192
    v_rcp_f32 v193, v193
    v_pk_fma_f32 v[28:29], v[140:141], v[184:185], v[188:189]
    v_exp_f32 v194, v28
    v_exp_f32 v195, v29
    v_pk_mul_f32 v[24:25], v[24:25], v[192:193]
    v_pk_add_f32 v[194:195], v[194:195], 1.0 op_sel_hi:[1,0]
    v_rcp_f32 v194, v194
    v_rcp_f32 v195, v195
    v_mov_b32_dpp v186, v84 row_newbcast:6 row_mask:0xf bank_mask:0xf
    v_mov_b32_dpp v190, v85 row_newbcast:6 row_mask:0xf bank_mask:0xf
    v_mov_b32_dpp v187, v84 row_newbcast:7 row_mask:0xf bank_mask:0xf
    v_mov_b32_dpp v191, v85 row_newbcast:7 row_mask:0xf bank_mask:0xf
    v_pk_fma_f32 v[26:27], v[138:139], v[186:187], v[190:191]
    v_exp_f32 v192, v26
    v_exp_f32 v193, v27
    v_pk_mul_f32 v[28:29], v[28:29], v[194:195]
    v_pk_add_f32 v[192:193], v[192:193], 1.0 op_sel_hi:[1,0]
    v_rcp_f32 v192, v192
    v_rcp_f32 v193, v193
    v_pk_fma_f32 v[30:31], v[142:143], v[186:187], v[190:191]
    v_exp_f32 v194, v30
    v_exp_f32 v195, v31
    v_pk_mul_f32 v[26:27], v[26:27], v[192:193]
    v_pk_add_f32 v[194:195], v[194:195], 1.0 op_sel_hi:[1,0]
    v_rcp_f32 v194, v194
    v_rcp_f32 v195, v195
    v_mov_b32_dpp v176, v84 row_newbcast:8 row_mask:0xf bank_mask:0xf
    v_mov_b32_dpp v180, v85 row_newbcast:8 row_mask:0xf bank_mask:0xf
    v_mov_b32_dpp v177, v84 row_newbcast:9 row_mask:0xf bank_mask:0xf
    v_mov_b32_dpp v181, v85 row_newbcast:9 row_mask:0xf bank_mask:0xf
    v_pk_fma_f32 v[32:33], v[144:145], v[176:177], v[180:181]
    v_exp_f32 v192, v32
    v_exp_f32 v193, v33
    v_pk_mul_f32 v[30:31], v[30:31], v[194:195]
    v_pk_add_f32 v[192:193], v[192:193], 1.0 op_sel_hi:[1,0]
    v_rcp_f32 v192, v192
    v_rcp_f32 v193, v193
    v_pk_fma_f32 v[36:37], v[148:149], v[176:177], v[180:181]
    v_exp_f32 v194, v36
    v_exp_f32 v195, v37
    v_pk_mul_f32 v[32:33], v[32:33], v[192:193]
    v_pk_add_f32 v[194:195], v[194:195], 1.0 op_sel_hi:[1,0]
    v_rcp_f32 v194, v194
    v_rcp_f32 v195, v195
    s_mov_b64 exec, 0xffff
    buffer_load_dwordx2 v[88:89], v247, s[16:19], s53 offen sc1
    s_mov_b64 exec, -1
    v_mov_b32_dpp v178, v84 row_newbcast:10 row_mask:0xf bank_mask:0xf
    v_mov_b32_dpp v182, v85 row_newbcast:10 row_mask:0xf bank_mask:0xf
    v_mov_b32_dpp v179, v84 row_newbcast:11 row_mask:0xf bank_mask:0xf
    v_mov_b32_dpp v183, v85 row_newbcast:11 row_mask:0xf bank_mask:0xf
    v_pk_fma_f32 v[34:35], v[146:147], v[178:179], v[182:183]
    v_exp_f32 v192, v34
    v_exp_f32 v193, v35
    buffer_load_dword v64, v249, s[16:19], s55 offen offset:0 sc1
    v_pk_mul_f32 v[36:37], v[36:37], v[194:195]
    v_pk_add_f32 v[192:193], v[192:193], 1.0 op_sel_hi:[1,0]
    v_rcp_f32 v192, v192
    v_rcp_f32 v193, v193
    buffer_load_dword v65, v249, s[16:19], s55 offen offset:1024 sc1
    buffer_load_dword v66, v249, s[16:19], s55 offen offset:2048 sc1
    v_pk_fma_f32 v[38:39], v[150:151], v[178:179], v[182:183]
    v_exp_f32 v194, v38
    v_exp_f32 v195, v39
    buffer_load_dword v67, v249, s[16:19], s55 offen offset:3072 sc1
    v_pk_mul_f32 v[34:35], v[34:35], v[192:193]
    v_pk_add_f32 v[194:195], v[194:195], 1.0 op_sel_hi:[1,0]
    v_rcp_f32 v194, v194
    v_rcp_f32 v195, v195
    buffer_load_dword v68, v249, s[16:19], s56 offen offset:0 sc1
    buffer_load_dword v69, v249, s[16:19], s56 offen offset:1024 sc1
    v_mov_b32_dpp v184, v84 row_newbcast:12 row_mask:0xf bank_mask:0xf
    v_mov_b32_dpp v188, v85 row_newbcast:12 row_mask:0xf bank_mask:0xf
    v_mov_b32_dpp v185, v84 row_newbcast:13 row_mask:0xf bank_mask:0xf
    v_mov_b32_dpp v189, v85 row_newbcast:13 row_mask:0xf bank_mask:0xf
    v_pk_fma_f32 v[40:41], v[152:153], v[184:185], v[188:189]
    v_exp_f32 v192, v40
    v_exp_f32 v193, v41
    buffer_load_dword v70, v249, s[16:19], s56 offen offset:2048 sc1
    v_pk_mul_f32 v[38:39], v[38:39], v[194:195]
    v_pk_add_f32 v[192:193], v[192:193], 1.0 op_sel_hi:[1,0]
    v_rcp_f32 v192, v192
    v_rcp_f32 v193, v193
    buffer_load_dword v71, v249, s[16:19], s56 offen offset:3072 sc1
    v_pk_fma_f32 v[44:45], v[156:157], v[184:185], v[188:189]
    v_exp_f32 v194, v44
    v_exp_f32 v195, v45
    v_pk_mul_f32 v[40:41], v[40:41], v[192:193]
    v_pk_add_f32 v[194:195], v[194:195], 1.0 op_sel_hi:[1,0]
    v_rcp_f32 v194, v194
    v_rcp_f32 v195, v195
    v_mov_b32_dpp v186, v84 row_newbcast:14 row_mask:0xf bank_mask:0xf
    v_mov_b32_dpp v190, v85 row_newbcast:14 row_mask:0xf bank_mask:0xf
    v_mov_b32_dpp v187, v84 row_newbcast:15 row_mask:0xf bank_mask:0xf
    v_mov_b32_dpp v191, v85 row_newbcast:15 row_mask:0xf bank_mask:0xf
    v_pk_fma_f32 v[42:43], v[154:155], v[186:187], v[190:191]
    v_exp_f32 v192, v42
    v_exp_f32 v193, v43
    v_pk_mul_f32 v[44:45], v[44:45], v[194:195]
    v_pk_add_f32 v[192:193], v[192:193], 1.0 op_sel_hi:[1,0]
    v_rcp_f32 v192, v192
    v_rcp_f32 v193, v193
    v_pk_fma_f32 v[46:47], v[158:159], v[186:187], v[190:191]
    v_exp_f32 v194, v46
    v_exp_f32 v195, v47
    v_pk_mul_f32 v[42:43], v[42:43], v[192:193]
    v_pk_add_f32 v[194:195], v[194:195], 1.0 op_sel_hi:[1,0]
    v_rcp_f32 v194, v194
    v_rcp_f32 v195, v195
    s_nop 0
    v_pk_mul_f32 v[46:47], v[46:47], v[194:195]
    s_branch L_pgc2
L_pg2:
    s_mov_b64 exec, 0xffff
    buffer_load_dwordx2 v[88:89], v247, s[16:19], s53 offen sc1
    s_mov_b64 exec, -1
    buffer_load_dword v64, v249, s[16:19], s55 offen offset:0 sc1
    buffer_load_dword v65, v249, s[16:19], s55 offen offset:1024 sc1
    buffer_load_dword v66, v249, s[16:19], s55 offen offset:2048 sc1
    buffer_load_dword v67, v249, s[16:19], s55 offen offset:3072 sc1
    buffer_load_dword v68, v249, s[16:19], s56 offen offset:0 sc1
    buffer_load_dword v69, v249, s[16:19], s56 offen offset:1024 sc1
    buffer_load_dword v70, v249, s[16:19], s56 offen offset:2048 sc1
    buffer_load_dword v71, v249, s[16:19], s56 offen offset:3072 sc1
    s_add_u32 s41, s41, 1
    s_cmp_gt_u32 s41, 65536
    s_cbranch_scc1 L_pgd2
L_pgc2:
    s_waitcnt vmcnt(8)
    v_cmp_ne_u32 vcc, s29, v89
    s_and_b32 s44, vcc_lo, 0xffff
    s_andn2_b64 exec, 0xffff, vcc
    ds_max_u32 v3, v88 offset:16388
    s_mov_b64 exec, -1
    s_waitcnt vmcnt(4)
    ds_write_b128 v240, v[64:67] offset:18432
    v_bitop3_b32 v2, v64, v65, s29 bitop3:0x7e
    v_bitop3_b32 v8, v66, v67, s29 bitop3:0x7e
    s_waitcnt vmcnt(2)
    v_bitop3_b32 v9, v68, v69, s29 bitop3:0x7e
    v_or3_b32 v2, v2, v8, v9
    s_waitcnt vmcnt(0)
    ds_write_b128 v240, v[68:71] offset:18944
    v_bitop3_b32 v10, v70, v71, s29 bitop3:0x7e
    v_or_b32 v2, v2, v10
    v_cmp_ne_u32 vcc, 0, v2
    s_or_b32 vcc_lo, vcc_lo, vcc_hi
    s_and_b32 vcc_lo, vcc_lo, 0x00010001
    s_or_b32 vcc_lo, vcc_lo, s44
    s_cbranch_scc0 L_pgd2
    s_waitcnt lgkmcnt(0)
    s_branch L_pg2
L_pgd2:
    s_waitcnt lgkmcnt(0)
    s_barrier
    ds_read_b128 v[192:195], v241 offset:18432
    ds_read_b128 v[196:199], v241 offset:19456
    ds_read_b128 v[200:203], v241 offset:20480
    ds_read_b128 v[204:207], v241 offset:21504
    ds_read_b128 v[208:211], v241 offset:22528
    ds_read_b128 v[212:215], v241 offset:23552
    ds_read_b128 v[216:219], v241 offset:24576
    ds_read_b128 v[220:223], v241 offset:25600
    ds_read_b32 v88, v3 offset:16388
    s_mov_b32 s48, 0xfffcfffc
    s_mov_b32 s49, s48
    s_waitcnt lgkmcnt(8)
    v_mfma_f32_16x16x32_bf16 v[48:51], v[96:99], v[192:195], 0
    s_waitcnt lgkmcnt(7)
    v_mfma_f32_16x16x32_bf16 v[52:55], v[96:99], v[196:199], 0
    s_waitcnt lgkmcnt(6)
    v_mfma_f32_16x16x32_bf16 v[48:51], v[100:103], v[200:203], v[48:51]
    s_waitcnt lgkmcnt(5)
    v_mfma_f32_16x16x32_bf16 v[52:55], v[100:103], v[204:207], v[52:55]
    s_waitcnt lgkmcnt(4)
    v_mfma_f32_16x16x32_bf16 v[48:51], v[104:107], v[208:211], v[48:51]
    s_waitcnt lgkmcnt(3)
    v_mfma_f32_16x16x32_bf16 v[52:55], v[104:107], v[212:215], v[52:55]
    s_waitcnt lgkmcnt(2)
    v_mfma_f32_16x16x32_bf16 v[48:51], v[108:111], v[216:219], v[48:51]
    s_waitcnt lgkmcnt(1)
    v_mfma_f32_16x16x32_bf16 v[52:55], v[108:111], v[220:223], v[52:55]
    v_mfma_f32_16x16x32_bf16 v[56:59], v[112:115], v[192:195], 0
    s_waitcnt lgkmcnt(0)
    v_readfirstlane_b32 s42, v88
    v_mfma_f32_16x16x32_bf16 v[60:63], v[112:115], v[196:199], 0
    s_lshl4_add_u32 s46, s37, s38
    s_andn2_b32 s40, 0x7ff, s42
    v_mfma_f32_16x16x32_bf16 v[56:59], v[116:119], v[200:203], v[56:59]
    s_sub_u32 s47, 0, s40
    s_xor_b32 s44, s40, s46
    v_mfma_f32_16x16x32_bf16 v[60:63], v[116:119], v[204:207], v[60:63]
    s_xor_b32 s45, s47, s46
    s_and_b32 s44, s44, 15
    v_mfma_f32_16x16x32_bf16 v[56:59], v[120:123], v[208:211], v[56:59]
    v_pk_fma_f32 v[24:25], v[48:49], v[24:25], v[136:137]
    v_pk_fma_f32 v[28:29], v[52:53], v[28:29], v[140:141]
    v_mfma_f32_16x16x32_bf16 v[60:63], v[120:123], v[212:215], v[60:63]
    v_cvt_pk_bf16_f32 v164, v28, v24
    v_cvt_pk_bf16_f32 v165, v29, v25
    v_mfma_f32_16x16x32_bf16 v[56:59], v[124:127], v[216:219], v[56:59]
    v_pk_fma_f32 v[26:27], v[50:51], v[26:27], v[138:139]
    v_pk_fma_f32 v[30:31], v[54:55], v[30:31], v[142:143]
    v_mfma_f32_16x16x32_bf16 v[60:63], v[124:127], v[220:223], v[60:63]
    v_cvt_pk_bf16_f32 v166, v30, v26
    v_cvt_pk_bf16_f32 v167, v31, v27
    v_mov_b32_dpp v64, v52 row_shr:1 row_mask:0xf bank_mask:0xf
    v_mov_b32_dpp v65, v53 row_shr:1 row_mask:0xf bank_mask:0xf
    v_mov_b32_dpp v66, v54 row_shr:1 row_mask:0xf bank_mask:0xf
    v_mov_b32_dpp v67, v55 row_shr:1 row_mask:0xf bank_mask:0xf
    s_and_b32 s45, s45, 15
    s_cmp_ge_u32 s28, 2
    s_cselect_b32 s9, s45, s44
    v_mov_b32_dpp v68, v60 row_shr:1 row_mask:0xf bank_mask:0xf
    v_mov_b32_dpp v69, v61 row_shr:1 row_mask:0xf bank_mask:0xf
    v_mov_b32_dpp v70, v62 row_shr:1 row_mask:0xf bank_mask:0xf
    v_mov_b32_dpp v71, v63 row_shr:1 row_mask:0xf bank_mask:0xf
    s_mov_b64 exec, s[48:49]
    buffer_store_dword v164, v245, s[20:23], 0 offen
    v_pk_fma_f32 v[16:17], v[48:49], v[16:17], v[128:129]
    v_pk_fma_f32 v[20:21], v[64:65], v[20:21], v[132:133]
    buffer_store_dword v165, v244, s[20:23], s96 offen
    v_cvt_pk_bf16_f32 v160, v20, v16
    v_cvt_pk_bf16_f32 v161, v21, v17
    buffer_store_dword v166, v244, s[20:23], s95 offen
    v_pk_fma_f32 v[18:19], v[50:51], v[18:19], v[130:131]
    v_pk_fma_f32 v[22:23], v[66:67], v[22:23], v[134:135]
    buffer_store_dword v167, v244, s[20:23], 0 offen
    v_cvt_pk_bf16_f32 v162, v22, v18
    v_cvt_pk_bf16_f32 v163, v23, v19
    buffer_store_dword v160, v243, s[20:23], 0 offen
    v_pk_fma_f32 v[40:41], v[56:57], v[40:41], v[152:153]
    v_pk_fma_f32 v[44:45], v[60:61], v[44:45], v[156:157]
    buffer_store_dword v161, v243, s[20:23], s95 offen
    v_cvt_pk_bf16_f32 v172, v44, v40
    v_cvt_pk_bf16_f32 v173, v45, v41
    buffer_store_dword v162, v243, s[20:23], s96 offen
    v_pk_fma_f32 v[42:43], v[58:59], v[42:43], v[154:155]
    v_pk_fma_f32 v[46:47], v[62:63], v[46:47], v[158:159]
    buffer_store_dword v163, v243, s[20:23], s97 offen
    v_cvt_pk_bf16_f32 v174, v46, v42
    v_cvt_pk_bf16_f32 v175, v47, v43
    buffer_store_dword v172, v252, s[20:23], s97 offen
    v_pk_fma_f32 v[32:33], v[56:57], v[32:33], v[144:145]
    v_pk_fma_f32 v[36:37], v[68:69], v[36:37], v[148:149]
    buffer_store_dword v173, v252, s[20:23], s96 offen
    v_cvt_pk_bf16_f32 v168, v36, v32
    v_cvt_pk_bf16_f32 v169, v37, v33
    buffer_store_dword v174, v252, s[20:23], s95 offen
    v_pk_fma_f32 v[34:35], v[58:59], v[34:35], v[146:147]
    v_pk_fma_f32 v[38:39], v[70:71], v[38:39], v[150:151]
    buffer_store_dword v175, v252, s[20:23], 0 offen
    v_cvt_pk_bf16_f32 v170, v38, v34
    v_cvt_pk_bf16_f32 v171, v39, v35
    buffer_store_dword v168, v251, s[20:23], 0 offen
    buffer_store_dword v169, v251, s[20:23], s95 offen
    buffer_store_dword v170, v251, s[20:23], s96 offen
    buffer_store_dword v171, v251, s[20:23], s97 offen
    s_cmp_lg_u32 s9, 0
    s_cbranch_scc1 L_nopl2
    s_mov_b64 exec, -1
    s_mul_i32 s11, s40, 896
    s_add_u32 s10, s10, s11
    buffer_load_ushort v91, v12, s[12:15], s10 offen
    s_and_b32 s11, s40, 127
    s_lshl_b32 s11, s11, 8
    s_lshr_b32 s46, s40, 7
    s_lshl4_add_u32 s11, s46, s11
    s_add_u32 s11, s11, 131072
    buffer_load_dwordx2 v[92:93], off, s[16:19], s11 sc1
    buffer_load_dwordx3 v[224:226], v248, s[16:19], s4 offen sc1
    buffer_load_dwordx3 v[228:230], v248, s[16:19], s5 offen sc1
    buffer_load_dwordx3 v[232:234], v248, s[16:19], s6 offen sc1
    s_mov_b32 exec_hi, 0
    buffer_load_dwordx3 v[236:238], v248, s[16:19], s7 offen sc1
    s_mov_b64 exec, s[48:49]
L_nopl2:
    s_mov_b64 exec, -1
    s_mul_i32 s46, s44, s45
    s_cmp_lg_u32 s46, 0
    s_cbranch_scc1 L_fin
    v_lshlrev_b32 v2, 5, v5
    s_bfe_u32 s48, s40, 0x20004
    s_cmp_lg_u32 s48, s28
    s_cbranch_scc1 L_norow02
    s_bfe_u32 s48, s40, 0x20009
    v_cmp_eq_u32 vcc, s48, v4
    s_mov_b64 exec, vcc
    ds_write_b128 v2, v[48:51] offset:16896
    ds_write_b128 v2, v[52:55] offset:16912
    s_bitcmp0_b32 s40, 6
    s_cbranch_scc1 L_rowd02
    ds_write_b128 v2, v[56:59] offset:16896
    ds_write_b128 v2, v[60:63] offset:16912
L_rowd02:
    s_mov_b64 exec, -1
L_norow02:
    s_bfe_u32 s48, s47, 0x20004
    s_cmp_lg_u32 s48, s28
    s_cbranch_scc1 L_norow12
    s_bfe_u32 s48, s47, 0x20009
    v_cmp_eq_u32 vcc, s48, v4
    s_mov_b64 exec, vcc
    ds_write_b128 v2, v[48:51] offset:17408
    ds_write_b128 v2, v[52:55] offset:17424
    s_bitcmp0_b32 s47, 6
    s_cbranch_scc1 L_rowd12
    ds_write_b128 v2, v[56:59] offset:17408
    ds_write_b128 v2, v[60:63] offset:17424
L_rowd12:
    s_mov_b64 exec, -1
L_norow12:
L_owner:
    s_cmp_eq_u32 s9, 0
    s_cbranch_scc1 L_own
    s_waitcnt lgkmcnt(0)
    s_barrier
    s_waitcnt vmcnt(0)
    s_barrier
    s_branch L_fin
L_own:
    s_and_b32 s46, s28, 1
    s_cmp_ge_u32 s28, 2
    s_cselect_b32 s45, -1, 0
    s_cselect_b32 s51, 512, 0
    s_cselect_b32 s47, s47, s40
    v_lshl_add_u32 v2, s46, 2, v13
    v_xor_b32 v2, s45, v2
    s_and_b32 s45, s45, 29
    v_add3_u32 v2, v2, s45, 3
    s_bfe_u32 s44, s47, 0x20007
    s_lshl2_add_u32 s51, s44, s51
    v_lshl_add_u32 v9, v2, 4, s51
    v_lshrrev_b32 v2, 2, v5
    v_and_b32 v3, 1, v2
    v_lshlrev_b32 v3, 4, v3
    v_mov_b32 v15, 0x3f80
    v_cmp_gt_u32 vcc, 2, v2
    v_lshlrev_b32 v15, v3, v15
    s_and_b32 s44, s42, 0xfffff800
    v_cndmask_b32 v208, 0, v15, vcc
    v_cndmask_b32 v209, v15, 0, vcc
    s_or_b32 s44, s44, 0x400
    s_ashr_i32 s45, s44, 31
    s_orn2_b32 s45, 0x80000000, s45
    s_xor_b32 s44, s44, s45
    v_mov_b32 v15, s44
    v_mul_f32 v15, s92, v15
    v_exp_f32 v15, v15
    s_lshr_b32 s47, 0x000f000f, s46
    v_add_f32 v15, 1.0, v15
    v_rcp_f32 v15, v15
    s_and_b32 s47, s47, 0x000f000f
    v_mul_f32 v15, s92, v15
    s_waitcnt lgkmcnt(0)
    s_barrier
    ds_read_b32 v90, v9 offset:16896
    v_mov_b32 v10, s29
    s_cmp_lt_u32 s2, 64
    s_cbranch_scc1 L_ppc
L_pp:
    buffer_load_dwordx3 v[224:226], v248, s[16:19], s4 offen sc1
    buffer_load_dwordx3 v[228:230], v248, s[16:19], s5 offen sc1
    buffer_load_dwordx3 v[232:234], v248, s[16:19], s6 offen sc1
    s_mov_b32 exec_hi, 0
    buffer_load_dwordx3 v[236:238], v248, s[16:19], s7 offen sc1
    s_mov_b64 exec, -1
    s_add_u32 s41, s41, 1
    s_cmp_gt_u32 s41, 65536
    s_cbranch_scc1 L_ppd
L_ppc:
    s_waitcnt vmcnt(3)
    v_mfma_f32_16x16x16_bf16 v[212:215], v[208:209], v[224:225], 0
    v_lshlrev_b32 v8, 16, v91
    s_waitcnt vmcnt(2)
    v_mfma_f32_16x16x16_bf16 v[212:215], v[208:209], v[228:229], v[212:215]
    v_fma_f32 v14, v8, v92, v93
    s_waitcnt vmcnt(1)
    v_mfma_f32_16x16x16_bf16 v[212:215], v[208:209], v[232:233], v[212:215]
    v_bitop3_b32 v2, v226, v230, s29 bitop3:0x7e
    s_waitcnt vmcnt(0)
    v_mfma_f32_16x16x16_bf16 v[212:215], v[208:209], v[236:237], v[212:215]
    v_bitop3_b32 v3, v234, v238, s29 bitop3:0x7e
    v_or_b32 v2, v2, v3
    v_cmp_ne_u32 vcc, 0, v2
    s_cbranch_vccnz L_pp
L_ppd:
    s_cmp_lg_u32 s8, 0
    s_cbranch_scc1 L_noep
    s_mov_b64 exec, 0x1
    buffer_store_dword v10, off, s[16:19], 0
    s_mov_b64 exec, -1
L_noep:
    s_barrier
    s_waitcnt lgkmcnt(0)
    v_add_f32_dpp v212, v212, v212 row_ror:4 row_mask:0xf bank_mask:0xf
    s_nop 1
    v_add_f32_dpp v212, v212, v212 row_ror:8 row_mask:0xf bank_mask:0xf
    v_fmac_f32 v14, v212, v15
    v_exp_f32 v3, v14
    v_mul_f32 v2, v14, v90
    v_add_f32 v3, 1.0, v3
    v_rcp_f32 v3, v3
    s_mov_b32 exec_lo, s47
    s_mov_b32 exec_hi, s47
    v_fma_f32 v2, v2, v3, v8
    v_cvt_pk_bf16_f32 v2, v2, v2
    buffer_store_short v2, v12, s[20:23], s10 offen
L_fin:
L_end:
    s_endpgm
L_m1f:
    v_and_b32 v172, s32, v168
    v_xor_b32 v168, v172, v168
    v_and_b32 v173, s32, v169
    v_xor_b32 v169, v173, v169
    v_and_b32 v174, s32, v170
    v_xor_b32 v170, v174, v170
    v_and_b32 v175, s32, v171
    v_xor_b32 v171, v175, v171
    v_cmp_lt_u32 vcc, 15, v0
    v_lshlrev_b32 v2, 15, v0
    v_and_b32 v2, 0x8000, v2
    v_cndmask_b32 v8, 0, v8, vcc
    s_mov_b64 exec, 0xffff
    v_xor_b32 v170, 0x3f31, v2
    s_branch L_m1d
L_ffn:
    s_cmp_ge_u32 s2, 248
    s_cbranch_scc1 L_end
    s_load_dwordx2 s[8:9], s[0:1], 72
    s_mul_i32 s31, s33, 7
    s_add_u32 s31, s31, s35
    s_sub_u32 s31, s31, 24
    s_lshr_b32 s46, s28, 1
    s_mov_b32 s10, s6
    s_mov_b32 s11, 0x20000
    v_mul_u32_u24 v7, 7168, v4
    v_min_u32 v2, 13, v5
    v_lshl_add_u32 v7, v2, 4, v7
    s_mul_i32 s26, s31, 28672
    s_mul_i32 s45, s28, 224
    s_add_u32 s26, s26, s45
    s_add_u32 s27, s26, 3584
    v_lshrrev_b32 v2, 2, v1
    v_mul_u32_u24 v2, 3584, v2
    v_and_b32 v3, 3, v0
    v_lshl_add_u32 v6, v3, 4, v2
    s_mul_i32 s47, s46, 802816
    s_lshl_b32 s48, s31, 6
    s_add_u32 s47, s47, s48
    s_mul_i32 s50, s28, 14336
    s_mov_b32 m0, s50
    s_waitcnt lgkmcnt(0)
    s_load_dword s29, s[16:17], 0
    buffer_load_dwordx4 v6, s[4:7], s47 offen lds
    s_add_u32 m0, m0, 1024
    s_add_u32 s47, s47, 57344
    buffer_load_dwordx4 v6, s[4:7], s47 offen lds
    s_add_u32 m0, m0, 1024
    s_add_u32 s47, s47, 57344
    buffer_load_dwordx4 v6, s[4:7], s47 offen lds
    s_add_u32 m0, m0, 1024
    s_add_u32 s47, s47, 57344
    buffer_load_dwordx4 v6, s[4:7], s47 offen lds
    s_add_u32 m0, m0, 1024
    s_add_u32 s47, s47, 57344
    v_mul_u32_u24 v8, 224, v4
    v_lshl_add_u32 v8, v5, 4, v8
    s_mul_i32 s36, s31, 1792
    s_mul_i32 s44, s28, 448
    s_add_u32 s36, s36, s44
    s_add_u32 s36, s36, 262144
    v_lshrrev_b32 v2, 2, v5
    v_lshlrev_b32 v2, 6, v2
    v_lshl_add_u32 v2, v3, 3, v2
    v_lshl_add_u32 v9, v4, 9, v2
    v_add_u32 v9, s50, v9
    v_lshlrev_b32 v10, 5, v1
    s_lshl_b32 s53, s33, 11
    s_add_u32 s53, s53, 65536
    v_lshlrev_b32 v11, 4, v4
    s_lshl_b32 s44, s28, 7
    v_add_u32 v12, s44, v11
    s_lshl_b32 s30, s28, 10
    s_add_u32 s30, s30, 58368
    v_add_u32 v11, s30, v11
    v_and_b32 v13, 7, v0
    v_lshlrev_b32 v13, 2, v13
    v_lshl_add_u32 v13, v4, 5, v13
    v_add_u32 v13, 57344, v13
    v_lshlrev_b32 v200, 4, v1
    s_mul_i32 s37, s46, 448
    s_mov_b32 s24, 0x05040100
    s_mov_b32 s25, 0x07060302
    v_mov_b32 v196, s43
    v_mov_b32 v197, s43
    v_mov_b32 v198, s43
    v_mov_b32 v199, s43
    s_waitcnt lgkmcnt(0)
    v_mov_b32 v180, s29
    v_mov_b32 v181, s29
    v_mov_b32 v182, s29
    v_mov_b32 v183, s29
    s_mov_b64 exec, 0x3fff3fff
    buffer_store_dwordx4 v[180:183], v8, s[16:19], s36 offen sc1
    s_mov_b64 exec, -1
    s_add_u32 s29, s29, 1
    s_barrier
    buffer_load_dwordx4 v6, s[4:7], s47 offen lds
    s_add_u32 m0, m0, 1024
    s_add_u32 s47, s47, 57344
    buffer_load_dwordx4 v6, s[4:7], s47 offen lds
    s_add_u32 m0, m0, 1024
    s_add_u32 s47, s47, 57344
    s_waitcnt vmcnt(5)
    ds_read_b64_tr_b16 v[16:17], v9 offset:0
    ds_read_b64_tr_b16 v[18:19], v9 offset:256
    ds_read_b64_tr_b16 v[20:21], v9 offset:32
    ds_read_b64_tr_b16 v[22:23], v9 offset:288
    buffer_load_dwordx4 v6, s[4:7], s47 offen lds
    s_add_u32 m0, m0, 1024
    s_add_u32 s47, s47, 57344
    buffer_load_dwordx4 v6, s[4:7], s47 offen lds
    s_add_u32 m0, m0, 1024
    s_add_u32 s47, s47, 57344
    s_waitcnt vmcnt(5)
    ds_read_b64_tr_b16 v[24:25], v9 offset:2048
    ds_read_b64_tr_b16 v[26:27], v9 offset:2304
    ds_read_b64_tr_b16 v[28:29], v9 offset:2080
    ds_read_b64_tr_b16 v[30:31], v9 offset:2336
    s_waitcnt lgkmcnt(4)
    v_mfma_f32_16x16x32_bf16 v[140:143], v[16:19], v[196:199], 0
    v_mfma_f32_16x16x32_bf16 v[144:147], v[20:23], v[196:199], 0
    buffer_load_dwordx4 v6, s[4:7], s47 offen lds
    s_add_u32 m0, m0, 1024
    s_add_u32 s47, s47, 57344
    buffer_load_dwordx4 v6, s[4:7], s47 offen lds
    s_add_u32 m0, m0, 1024
    s_add_u32 s47, s47, 57344
    s_waitcnt vmcnt(4)
    ds_read_b64_tr_b16 v[32:33], v9 offset:4096
    ds_read_b64_tr_b16 v[34:35], v9 offset:4352
    ds_read_b64_tr_b16 v[36:37], v9 offset:4128
    ds_read_b64_tr_b16 v[38:39], v9 offset:4384
    s_waitcnt lgkmcnt(4)
    v_mfma_f32_16x16x32_bf16 v[140:143], v[24:27], v[196:199], v[140:143]
    v_mfma_f32_16x16x32_bf16 v[144:147], v[28:31], v[196:199], v[144:147]
    buffer_load_dwordx4 v6, s[4:7], s47 offen lds
    s_add_u32 m0, m0, 1024
    s_add_u32 s47, s47, 57344
    buffer_load_dwordx4 v6, s[4:7], s47 offen lds
    s_add_u32 m0, m0, 1024
    s_add_u32 s47, s47, 57344
    s_waitcnt vmcnt(4)
    ds_read_b64_tr_b16 v[40:41], v9 offset:6144
    ds_read_b64_tr_b16 v[42:43], v9 offset:6400
    ds_read_b64_tr_b16 v[44:45], v9 offset:6176
    ds_read_b64_tr_b16 v[46:47], v9 offset:6432
    s_waitcnt lgkmcnt(4)
    v_mfma_f32_16x16x32_bf16 v[140:143], v[32:35], v[196:199], v[140:143]
    v_mfma_f32_16x16x32_bf16 v[144:147], v[36:39], v[196:199], v[144:147]
    buffer_load_dwordx2 v[192:193], v10, s[16:19], s53 offen sc1
    buffer_load_dwordx4 v6, s[4:7], s47 offen lds
    s_add_u32 m0, m0, 1024
    s_add_u32 s47, s47, 57344
    buffer_load_dwordx4 v6, s[4:7], s47 offen lds
    s_waitcnt vmcnt(5)
    ds_read_b64_tr_b16 v[48:49], v9 offset:8192
    ds_read_b64_tr_b16 v[50:51], v9 offset:8448
    ds_read_b64_tr_b16 v[52:53], v9 offset:8224
    ds_read_b64_tr_b16 v[54:55], v9 offset:8480
    s_waitcnt lgkmcnt(4)
    v_mfma_f32_16x16x32_bf16 v[140:143], v[40:43], v[196:199], v[140:143]
    v_mfma_f32_16x16x32_bf16 v[144:147], v[44:47], v[196:199], v[144:147]
    s_waitcnt vmcnt(3)
    ds_read_b64_tr_b16 v[56:57], v9 offset:10240
    ds_read_b64_tr_b16 v[58:59], v9 offset:10496
    ds_read_b64_tr_b16 v[60:61], v9 offset:10272
    ds_read_b64_tr_b16 v[62:63], v9 offset:10528
    s_waitcnt lgkmcnt(4)
    v_mfma_f32_16x16x32_bf16 v[140:143], v[48:51], v[196:199], v[140:143]
    v_mfma_f32_16x16x32_bf16 v[144:147], v[52:55], v[196:199], v[144:147]
    s_mov_b32 m0, s30
    s_waitcnt vmcnt(2)
    v_cmp_ne_u32 vcc, s29, v193
    s_nop 1
    v_cndmask_b32 v2, v192, 0, vcc
    s_nop 1
    v_max_u32_dpp v2, v2, v2 row_shr:1 row_mask:0xf bank_mask:0xf
    s_nop 1
    v_max_u32_dpp v2, v2, v2 row_shr:2 row_mask:0xf bank_mask:0xf
    s_nop 1
    v_max_u32_dpp v2, v2, v2 row_shr:4 row_mask:0xf bank_mask:0xf
    s_nop 1
    v_max_u32_dpp v2, v2, v2 row_shr:8 row_mask:0xf bank_mask:0xf
    s_nop 1
    v_max_u32_dpp v2, v2, v2 row_bcast:15 row_mask:0xa bank_mask:0xf
    s_nop 1
    v_max_u32_dpp v2, v2, v2 row_bcast:31 row_mask:0xc bank_mask:0xf
    s_nop 0
    v_readlane_b32 s42, v2, 63
    s_andn2_b32 s49, 0x7ff, s42
    s_mov_b32 s40, s49
    s_mul_i32 s44, s40, 896
    s_add_u32 s44, s44, s37
    s_mov_b64 exec, 0xfffffff
    buffer_load_dwordx4 v200, s[12:15], s44 offen lds
    s_mov_b64 exec, -1
    s_and_b32 s45, s40, 127
    s_lshl_b32 s45, s45, 8
    s_lshr_b32 s49, s40, 7
    s_lshl4_add_u32 s45, s49, s45
    s_add_u32 s45, s45, 131072
    buffer_load_dwordx4 v[176:179], off, s[16:19], s45 sc1
    s_cbranch_vccz L_nrk
    s_mov_b64 exec, vcc
    buffer_load_dwordx2 v[192:193], v10, s[16:19], s53 offen sc1
    s_mov_b64 exec, -1
    s_waitcnt vmcnt(3)
    s_branch L_w3
L_nrk:
    s_waitcnt vmcnt(2)
L_w3:
    ds_read_b64_tr_b16 v[64:65], v9 offset:12288
    ds_read_b64_tr_b16 v[66:67], v9 offset:12544
    ds_read_b64_tr_b16 v[68:69], v9 offset:12320
    ds_read_b64_tr_b16 v[70:71], v9 offset:12576
    s_waitcnt lgkmcnt(4)
    v_mfma_f32_16x16x32_bf16 v[140:143], v[56:59], v[196:199], v[140:143]
    v_mfma_f32_16x16x32_bf16 v[144:147], v[60:63], v[196:199], v[144:147]
    s_waitcnt lgkmcnt(0)
    v_mfma_f32_16x16x32_bf16 v[140:143], v[64:67], v[196:199], v[140:143]
    v_mfma_f32_16x16x32_bf16 v[144:147], v[68:71], v[196:199], v[144:147]
    s_cbranch_vccz L_fkd
    s_branch L_fkc
L_fk:
    s_mov_b64 exec, vcc
    buffer_load_dwordx2 v[192:193], v10, s[16:19], s53 offen sc1
    s_mov_b64 exec, -1
    s_add_u32 s41, s41, 1
    s_cmp_gt_u32 s41, 65536
    s_cbranch_scc1 L_fkd
L_fkc:
    s_waitcnt vmcnt(0)
    v_cmp_ne_u32 vcc, s29, v193
    s_nop 1
    v_cndmask_b32 v2, v192, 0, vcc
    s_nop 1
    v_max_u32_dpp v2, v2, v2 row_shr:1 row_mask:0xf bank_mask:0xf
    s_nop 1
    v_max_u32_dpp v2, v2, v2 row_shr:2 row_mask:0xf bank_mask:0xf
    s_nop 1
    v_max_u32_dpp v2, v2, v2 row_shr:4 row_mask:0xf bank_mask:0xf
    s_nop 1
    v_max_u32_dpp v2, v2, v2 row_shr:8 row_mask:0xf bank_mask:0xf
    s_nop 1
    v_max_u32_dpp v2, v2, v2 row_bcast:15 row_mask:0xa bank_mask:0xf
    s_nop 1
    v_max_u32_dpp v2, v2, v2 row_bcast:31 row_mask:0xc bank_mask:0xf
    s_nop 0
    v_readlane_b32 s42, v2, 63
    s_andn2_b32 s49, 0x7ff, s42
    s_cmp_eq_u32 s49, s40
    s_cbranch_scc1 L_fsame
    s_mov_b32 s40, s49
    s_mul_i32 s44, s40, 896
    s_add_u32 s44, s44, s37
    s_mov_b64 exec, 0xfffffff
    buffer_load_dwordx4 v200, s[12:15], s44 offen lds
    s_mov_b64 exec, -1
    s_and_b32 s45, s40, 127
    s_lshl_b32 s45, s45, 8
    s_lshr_b32 s49, s40, 7
    s_lshl4_add_u32 s45, s49, s45
    s_add_u32 s45, s45, 131072
    buffer_load_dwordx4 v[176:179], off, s[16:19], s45 sc1
L_fsame:
    s_cbranch_vccnz L_fk
L_fkd:
    buffer_load_dwordx4 v[72:75], v7, s[8:11], s26 offen offset:0
    buffer_load_dwordx4 v[76:79], v7, s[8:11], s26 offen offset:896
    buffer_load_dwordx4 v[80:83], v7, s[8:11], s26 offen offset:1792
    buffer_load_dwordx4 v[84:87], v7, s[8:11], s26 offen offset:2688
    buffer_load_dwordx4 v[88:91], v7, s[8:11], s27 offen offset:0
    buffer_load_dwordx4 v[92:95], v7, s[8:11], s27 offen offset:896
    buffer_load_dwordx4 v[96:99], v7, s[8:11], s27 offen offset:1792
    buffer_load_dwordx4 v[100:103], v7, s[8:11], s27 offen offset:2688
    s_waitcnt vmcnt(9)
    ds_read_b128 v[148:151], v11 offset:0
    ds_read_b128 v[152:155], v11 offset:64
    ds_read_b128 v[156:159], v11 offset:128
    ds_read_b128 v[160:163], v11 offset:192
    ds_read_b128 v[164:167], v11 offset:256
    ds_read_b128 v[168:171], v11 offset:320
    ds_read_b128 v[172:175], v11 offset:384
    s_waitcnt vmcnt(8)
    s_branch L_fsc
L_fs:
    buffer_load_dwordx4 v[176:179], off, s[16:19], s45 sc1
    s_add_u32 s41, s41, 1
    s_cmp_gt_u32 s41, 65536
    s_cbranch_scc1 L_fsd
    s_waitcnt vmcnt(0)
L_fsc:
    v_pk_mul_f32 v[180:181], v[178:179], v[140:141] op_sel_hi:[0,1]
    v_pk_mul_f32 v[182:183], v[178:179], v[142:143] op_sel_hi:[0,1]
    v_pk_mul_f32 v[184:185], v[178:179], v[144:145] op_sel_hi:[0,1]
    v_pk_mul_f32 v[186:187], v[178:179], v[146:147] op_sel_hi:[0,1]
    v_cmp_ne_u32 vcc, s29, v179
    s_cbranch_vccnz L_fs
L_fsd:
    s_waitcnt lgkmcnt(6)
    v_mfma_f32_16x16x32_bf16 v[180:183], v[16:19], v[148:151], v[180:183]
    v_mfma_f32_16x16x32_bf16 v[184:187], v[20:23], v[148:151], v[184:187]
    s_waitcnt lgkmcnt(5)
    v_mfma_f32_16x16x32_bf16 v[180:183], v[24:27], v[152:155], v[180:183]
    v_mfma_f32_16x16x32_bf16 v[184:187], v[28:31], v[152:155], v[184:187]
    s_waitcnt lgkmcnt(4)
    v_mfma_f32_16x16x32_bf16 v[180:183], v[32:35], v[156:159], v[180:183]
    v_mfma_f32_16x16x32_bf16 v[184:187], v[36:39], v[156:159], v[184:187]
    s_waitcnt lgkmcnt(3)
    v_mfma_f32_16x16x32_bf16 v[180:183], v[40:43], v[160:163], v[180:183]
    v_mfma_f32_16x16x32_bf16 v[184:187], v[44:47], v[160:163], v[184:187]
    s_waitcnt lgkmcnt(2)
    v_mfma_f32_16x16x32_bf16 v[180:183], v[48:51], v[164:167], v[180:183]
    v_mfma_f32_16x16x32_bf16 v[184:187], v[52:55], v[164:167], v[184:187]
    s_waitcnt lgkmcnt(1)
    v_mfma_f32_16x16x32_bf16 v[180:183], v[56:59], v[168:171], v[180:183]
    v_mfma_f32_16x16x32_bf16 v[184:187], v[60:63], v[168:171], v[184:187]
    s_waitcnt lgkmcnt(0)
    v_mfma_f32_16x16x32_bf16 v[180:183], v[64:67], v[172:175], v[180:183]
    v_mfma_f32_16x16x32_bf16 v[184:187], v[68:71], v[172:175], v[184:187]
    v_mul_f32 v15, 0x3ef5fdf0, v176
    v_mul_f32 v15, v15, v176
    s_mov_b32 exec_lo, 0x10001
    s_mov_b32 exec_hi, 0x10001
    s_nop 2
    ds_write_b128 v12, v[180:183] offset:57344
    ds_write_b128 v12, v[184:187] offset:57408
    s_mov_b64 exec, -1
    s_waitcnt lgkmcnt(0)
    s_barrier
    ds_read2_b32 v[2:3], v13 offset0:0 offset1:64
    ds_read2_b32 v[6:7], v13 offset0:32 offset1:96
    s_waitcnt vmcnt(0)
    v_perm_b32 v104, v76, v72, s24
    v_perm_b32 v105, v84, v80, s24
    v_perm_b32 v106, v92, v88, s24
    v_perm_b32 v107, v100, v96, s24
    v_perm_b32 v108, v76, v72, s25
    v_perm_b32 v109, v84, v80, s25
    v_perm_b32 v110, v92, v88, s25
    v_perm_b32 v111, v100, v96, s25
    v_perm_b32 v112, v77, v73, s24
    v_perm_b32 v113, v85, v81, s24
    v_perm_b32 v114, v93, v89, s24
    v_perm_b32 v115, v101, v97, s24
    s_waitcnt lgkmcnt(0)
    v_add_f32 v2, v2, v3
    v_mul_f32 v3, v176, v2
    v_exp_f32 v3, v3
    v_add_f32 v6, v6, v7
    v_add_f32 v3, 1.0, v3
    v_rcp_f32 v3, v3
    v_mul_f32 v2, v2, v6
    v_mul_f32 v2, v2, v15
    v_mul_f32 v2, v2, v3
    v_perm_b32 v116, v77, v73, s25
    v_perm_b32 v117, v85, v81, s25
    v_mov_b32_dpp v3, v2 quad_perm:[1,1,3,3] row_mask:0xf bank_mask:0xf
    v_cvt_pk_bf16_f32 v2, v2, v3
    v_perm_b32 v118, v93, v89, s25
    v_perm_b32 v119, v101, v97, s25
    v_mov_b32_dpp v188, v2 row_newbcast:0 row_mask:0xf bank_mask:0xf
    v_mov_b32_dpp v189, v2 row_newbcast:2 row_mask:0xf bank_mask:0xf
    v_mov_b32_dpp v190, v2 row_newbcast:4 row_mask:0xf bank_mask:0xf
    v_mov_b32_dpp v191, v2 row_newbcast:6 row_mask:0xf bank_mask:0xf
    v_perm_b32 v120, v78, v74, s24
    v_perm_b32 v121, v86, v82, s24
    v_mfma_f32_16x16x32_bf16 v[204:207], v[188:191], v[104:107], 0
    v_perm_b32 v122, v94, v90, s24
    v_perm_b32 v123, v102, v98, s24
    v_perm_b32 v124, v78, v74, s25
    v_mfma_f32_16x16x32_bf16 v[208:211], v[188:191], v[108:111], 0
    v_perm_b32 v125, v86, v82, s25
    v_perm_b32 v126, v94, v90, s25
    v_perm_b32 v127, v102, v98, s25
    v_mfma_f32_16x16x32_bf16 v[212:215], v[188:191], v[112:115], 0
    v_perm_b32 v128, v79, v75, s24
    v_perm_b32 v129, v87, v83, s24
    v_perm_b32 v130, v95, v91, s24
    v_mfma_f32_16x16x32_bf16 v[216:219], v[188:191], v[116:119], 0
    v_perm_b32 v131, v103, v99, s24
    v_perm_b32 v132, v79, v75, s25
    v_perm_b32 v133, v87, v83, s25
    v_mfma_f32_16x16x32_bf16 v[220:223], v[188:191], v[120:123], 0
    v_perm_b32 v134, v95, v91, s25
    v_perm_b32 v135, v103, v99, s25
    v_mfma_f32_16x16x32_bf16 v[224:227], v[188:191], v[124:127], 0
    v_mfma_f32_16x16x32_bf16 v[228:231], v[188:191], v[128:131], 0
    v_mfma_f32_16x16x32_bf16 v[232:235], v[188:191], v[132:135], 0
    v_mov_b32 v182, s29
    v_cvt_pk_bf16_f32 v180, v204, v208
    v_cvt_pk_bf16_f32 v181, v212, v216
    s_mov_b64 exec, 0x3fff0000
    s_nop 1
    v_cvt_pk_bf16_f32 v180, v220, v224
    s_nop 0
    v_cvt_pk_bf16_f32 v181, v228, v232
    s_mov_b32 exec_lo, 0x3fff3fff
    buffer_store_dwordx4 v[180:183], v8, s[16:19], s36 offen sc1
    s_endpgm
L_codeend:
.section .rodata,"a"
.p2align 6
.amdhsa_kernel recurrent_scan__spectral_fnet__moe_arch_mod__prompt_kernel
  .amdhsa_next_free_vgpr 256
  .amdhsa_next_free_sgpr 102
  .amdhsa_accum_offset 256
  .amdhsa_group_segment_fixed_size 0
  .amdhsa_kernarg_size 104
  .amdhsa_user_sgpr_count 2
  .amdhsa_user_sgpr_kernarg_segment_ptr 1
  .amdhsa_system_sgpr_workgroup_id_x 1
.end_amdhsa_kernel
```
